```python
import torch

def _softmax(x, axis=-1):
    return torch.softmax(x, dim=axis)
def _gelu(x):
    return torch.nn.functional.gelu(x, approximate="tanh")
def _silu(x):
    return torch.nn.functional.silu(x)
def _sigmoid(x):
    return torch.sigmoid(x)
def _layernorm(x, axis=-1, eps=1e-5):
    m = x.mean(dim=axis, keepdim=True)
    v = x.var(dim=axis, keepdim=True, unbiased=False)
    return (x - m) / torch.sqrt(v + eps)
def _scatter_add(tgt, idx, src, axis=0):
    return tgt.clone().index_add_(axis, idx, src)
def _segment_sum(src, seg, n):
    out = torch.zeros((n,) + src.shape[1:], dtype=src.dtype)
    return out.index_add_(0, seg, src)
def _pad(x, pw):
    flat = tuple(v for pair in reversed(pw) for v in pair)
    return torch.nn.functional.pad(x, flat)

kernel_name = 'recurrent_scan__linear_kernel_hedgehog__mixer_channel_mlp__prompt'

def setup_inputs():

    _w = (lambda a: (lambda t: t.to(torch.bfloat16) if t.is_floating_point() else t)(torch.as_tensor(a)))
    def _A_setup():
        B, S, D, H = 1, 2048, 512, 32
        Dh = D // H
        return {
            "x": _w((lambda *s: torch.randn(*s, dtype=torch.bfloat16) * 0.05)(B, S, D)),
            "wqkv": _w((lambda *s: torch.randn(*s, dtype=torch.bfloat16) * 0.2)(D, 3 * D)),
            "w_phi": _w((lambda *s: torch.randn(*s, dtype=torch.bfloat16) * 0.2)(H, Dh, Dh) * (Dh ** -0.5)),
            "wo": _w((lambda *s: torch.randn(*s, dtype=torch.bfloat16) * 0.2)(D, D)),
        }
    _A_in = _A_setup()

    def _B_setup():
        B, S, D, F = 1, 2048, 512, 1376
        return {
            "x": _w((lambda *s: torch.randn(*s, dtype=torch.bfloat16) * 0.05)(B, S, D)),
            "w1": _w((lambda *s: torch.randn(*s, dtype=torch.bfloat16) * 0.8)(D, F) * (D ** -0.5)),
            "b1": _w((lambda *s: torch.randn(*s, dtype=torch.bfloat16) * 0.8)(F)),
            "w2": _w((lambda *s: torch.randn(*s, dtype=torch.bfloat16) * 0.1)(F, D) * (F ** -0.5)),
            "b2": _w((lambda *s: torch.randn(*s, dtype=torch.bfloat16) * 0.1)(D)),
        }
    _B_in = _B_setup()

    return {
        "A_x": _A_in["x"],
        "A_wqkv": _A_in["wqkv"],
        "A_w_phi": _A_in["w_phi"],
        "A_wo": _A_in["wo"],
        "B_x": _B_in["x"],
        "B_w1": _B_in["w1"],
        "B_b1": _B_in["b1"],
        "B_w2": _B_in["w2"],
        "B_b2": _B_in["b2"],
    }

def reference(A_x, A_wqkv, A_w_phi, A_wo, B_x, B_w1, B_b1, B_w2, B_b2):
    def _A_ref(x, wqkv, w_phi, wo):
        B, S, D = x.shape
        H = 32; Dh = D // H
        qkv = (lambda x, *d: x.permute(*d))((x @ wqkv).reshape(B, S, 3, H, Dh), 2, 0, 3, 1, 4)
        q, k, v = qkv[0], qkv[1], qkv[2]
        pq = torch.einsum("bhsd,hdf->bhsf", q, w_phi)
        pk = torch.einsum("bhsd,hdf->bhsf", k, w_phi)
        phi_q = torch.concatenate([_softmax(pq, axis=-1), _softmax(-pq, axis=-1)], axis=-1)
        phi_k = torch.concatenate([_softmax(pk, axis=-1), _softmax(-pk, axis=-1)], axis=-1)
        kv = torch.einsum("bhsf,bhsd->bhfd", phi_k, v)
        z  = torch.einsum("bhsf->bhf", phi_k)
        num = torch.einsum("bhqf,bhfd->bhqd", phi_q, kv)
        den = torch.einsum("bhqf,bhf->bhq", phi_q, z)[..., None] + 1e-6
        o = num / den
        return (lambda x, *d: x.permute(*d))(o, 0, 2, 1, 3).reshape(B, S, D) @ wo

    def _B_ref(x, w1, b1, w2, b2):
        y = _layernorm(x, axis=-1)
        h = _gelu(torch.einsum("bsd,df->bsf", y, w1) + b1)
        return torch.einsum("bsf,fd->bsd", h, w2) + b2

    x = A_x
    xn = _layernorm(x, axis=-1)
    s = _A_ref(xn, A_wqkv, A_w_phi, A_wo)
    g = _silu(_B_ref(xn, B_w1, B_b1, B_w2, B_b2))
    return x + s * g
```

```asm
; @launch grid=(256,1,1) block=(512,1,1) lds=163840
.amdgcn_target "amdgcn-amd-amdhsa--gfx950"
.text
.globl recurrent_scan__linear_kernel_hedgehog__mixer_channel_mlp__prompt_kernel
.p2align 8
.type recurrent_scan__linear_kernel_hedgehog__mixer_channel_mlp__prompt_kernel,@function
recurrent_scan__linear_kernel_hedgehog__mixer_channel_mlp__prompt_kernel:
    s_cmp_ge_u32 s2, 256
    s_cbranch_scc1 K1_EXIT
    s_load_dwordx16 s[32:47], s[0:1], 0
    s_load_dwordx8 s[48:55], s[0:1], 64
    v_and_b32 v1, 63, v0
    v_lshrrev_b32 v2, 6, v0
    s_and_b32 s63, s2, 7
    s_lshr_b32 s64, s2, 3
    v_readfirstlane_b32 s58, v2
    s_lshr_b32 s56, s63, 0
    s_lshl_b32 s56, s56, 1
    s_and_b32 s65, s64, 1
    s_add_u32 s56, s56, s65
    s_and_b32 s57, s63, 0
    s_lshl_b32 s57, s57, 4
    s_lshr_b32 s65, s64, 1
    s_add_u32 s57, s57, s65
    s_and_b32 s59, s58, 3
    s_lshr_b32 s60, s58, 2
    s_lshl_b32 s66, s58, 11
    s_lshl_b32 s67, s58, 10
    s_add_u32 s67, s67, 0x10000
    s_mov_b32 s70, 0x3f803f80
    s_lshl_b32 s83, s57, 0
    s_add_u32 s83, s83, s56
    s_mul_i32 s83, s83, 2
    v_lshrrev_b32 v2, 3, v1
    v_and_b32 v3, 7, v1
    v_lshrrev_b32 v4, 4, v1
    v_xor_b32 v5, v3, v4
    s_lshl_b32 s65, s58, 14
    v_lshlrev_b32 v6, 10, v2
    v_add_u32 v6, s65, v6
    v_xor_b32 v7, 4, v5
    v_lshl_add_u32 v7, v7, 4, v6
    v_add_u32 v7, 7168, v7
    v_lshl_add_u32 v6, v5, 4, v6
    v_and_b32 v4, 1, v4
    v_lshlrev_b32 v4, 2, v4
    v_xor_b32 v3, v3, v4
    v_lshlrev_b32 v3, 4, v3
    s_lshl_b32 s65, s58, 3
    v_add_u32 v2, s65, v2
    s_cmp_lt_u32 s57, 8
    s_movk_i32 s68, 2752
    s_cselect_b32 s68, 3072, s68
    v_mul_lo_u32 v8, v2, s68
    v_add_u32 v8, v8, v3
    v_mov_b32 v9, v8
    s_lshl_b32 s61, s68, 6
    s_mov_b32 s62, s61
    s_lshl_b32 s65, s56, 17
    s_waitcnt lgkmcnt(0)
    s_add_u32 s4, s32, s65
    s_addc_u32 s5, s33, 0
    s_mov_b32 s6, 131072
    s_mov_b32 s7, 0x00020000
    s_add_u32 s20, s54, 0
    s_addc_u32 s21, s55, 0
    s_mov_b32 s22, 16777216
    s_mov_b32 s23, 0x00020000
    s_add_u32 s28, s52, 0
    s_addc_u32 s29, s53, 0
    s_mov_b32 s30, 256
    s_mov_b32 s31, 0x00020000
    s_cmp_lt_u32 s57, 8
    s_cbranch_scc0 K1_MLP
    s_lshl_b32 s65, s57, 7
    s_sub_u32 s64, 1572864, s65
    s_add_u32 s8, s34, s65
    s_addc_u32 s9, s35, 0
    s_mov_b32 s10, s64
    s_mov_b32 s11, 0x00020000
    s_add_u32 s65, s65, 1024
    s_sub_u32 s64, 1572864, s65
    s_add_u32 s12, s34, s65
    s_addc_u32 s13, s35, 0
    s_mov_b32 s14, s64
    s_mov_b32 s15, 0x00020000
    s_add_u32 s65, s65, 1024
    s_sub_u32 s64, 1572864, s65
    s_add_u32 s16, s34, s65
    s_addc_u32 s17, s35, 0
    s_mov_b32 s18, s64
    s_mov_b32 s19, 0x00020000
    s_add_u32 s74, s83, 0
    s_and_b32 s74, s74, 7
    s_lshl_b32 s71, s74, 7
    s_mul_i32 s72, s74, s61
    s_mul_i32 s73, s74, s62
    s_add_u32 m0, s66, 0
    s_nop 0
    buffer_load_dwordx4 v6, s[4:7], s71 offen offset:0 lds
    s_add_u32 m0, s66, 0
    s_nop 0
    buffer_load_dwordx4 v7, s[4:7], s71 offen offset:1024 lds
    s_add_u32 m0, s67, 0
    s_nop 0
    buffer_load_dwordx4 v8, s[8:11], s72 offen lds
    s_add_u32 m0, s67, 8192
    s_nop 0
    buffer_load_dwordx4 v9, s[12:15], s73 offen lds
    s_add_u32 m0, s67, 16384
    s_nop 0
    buffer_load_dwordx4 v9, s[16:19], s73 offen lds
    s_add_u32 s74, s83, 1
    s_and_b32 s74, s74, 7
    s_lshl_b32 s71, s74, 7
    s_mul_i32 s72, s74, s61
    s_mul_i32 s73, s74, s62
    s_add_u32 m0, s66, 16384
    s_nop 0
    buffer_load_dwordx4 v6, s[4:7], s71 offen offset:0 lds
    s_add_u32 m0, s66, 16384
    s_nop 0
    buffer_load_dwordx4 v7, s[4:7], s71 offen offset:1024 lds
    s_add_u32 m0, s67, 24576
    s_nop 0
    buffer_load_dwordx4 v8, s[8:11], s72 offen lds
    s_add_u32 m0, s67, 32768
    s_nop 0
    buffer_load_dwordx4 v9, s[12:15], s73 offen lds
    s_add_u32 m0, s67, 40960
    s_nop 0
    buffer_load_dwordx4 v9, s[16:19], s73 offen lds
    s_add_u32 s24, s36, 0
    s_addc_u32 s25, s37, 0
    s_mov_b32 s26, 16384
    s_mov_b32 s27, 0x00020000
    s_lshr_b32 s64, s58, 1
    s_lshl_b32 s64, s64, 4
    s_and_b32 s65, s58, 1
    s_lshl_b32 s65, s65, 2
    s_add_u32 s64, s64, s65
    v_lshrrev_b32 v2, 5, v1
    v_bfe_u32 v4, v1, 3, 2
    v_lshl_add_u32 v2, v2, 3, v4
    v_add_u32 v2, s64, v2
    v_lshl_add_u32 v26, v2, 10, v3
    v_lshlrev_b32 v27, 4, v1
    s_lshl_b32 s75, s57, 2
    s_xor_b32 s76, s56, s57
    s_or_b32 s76, s76, s58
    s_cmp_lg_u32 s76, 0
    s_cbranch_scc1 K1_Z1
    s_mul_i32 s64, s57, 10240
    s_add_u32 s64, s64, 10485760
    v_mov_b32 v132, 0
    v_mov_b32 v133, 0
    v_mov_b32 v134, 0
    v_mov_b32 v135, 0
    buffer_store_dwordx4 v[132:135], v27, s[20:23], s64 offen offset:0 sc1
    buffer_store_dwordx4 v[132:135], v27, s[20:23], s64 offen offset:1024 sc1
    buffer_store_dwordx4 v[132:135], v27, s[20:23], s64 offen offset:2048 sc1
    buffer_store_dwordx4 v[132:135], v27, s[20:23], s64 offen offset:3072 sc1
    s_add_u32 s64, s64, 4096
    buffer_store_dwordx4 v[132:135], v27, s[20:23], s64 offen offset:0 sc1
    buffer_store_dwordx4 v[132:135], v27, s[20:23], s64 offen offset:1024 sc1
    buffer_store_dwordx4 v[132:135], v27, s[20:23], s64 offen offset:2048 sc1
    buffer_store_dwordx4 v[132:135], v27, s[20:23], s64 offen offset:3072 sc1
    s_add_u32 s64, s64, 4096
    buffer_store_dwordx4 v[132:135], v27, s[20:23], s64 offen offset:0 sc1
    buffer_store_dwordx4 v[132:135], v27, s[20:23], s64 offen offset:1024 sc1
K1_Z1:
    s_lshl_b32 s69, s60, 1
    s_xor_b32 s69, s69, s59
    v_and_b32 v29, 31, v1
    v_lshrrev_b32 v28, 5, v1
    s_lshl_b32 s65, s59, 12
    v_lshrrev_b32 v2, 1, v29
    v_and_b32 v2, 7, v2
    v_xor_b32 v2, v2, v28
    v_lshlrev_b32 v3, 7, v29
    v_add_u32 v3, s65, v3
    s_xor_b32 s65, s69, 0
    s_lshl_b32 s65, s65, 1
    v_xor_b32 v4, s65, v2
    v_lshl_add_u32 v10, v4, 4, v3
    s_xor_b32 s65, s69, 1
    s_lshl_b32 s65, s65, 1
    v_xor_b32 v4, s65, v2
    v_lshl_add_u32 v11, v4, 4, v3
    s_xor_b32 s65, s69, 2
    s_lshl_b32 s65, s65, 1
    v_xor_b32 v4, s65, v2
    v_lshl_add_u32 v12, v4, 4, v3
    s_xor_b32 s65, s69, 3
    s_lshl_b32 s65, s65, 1
    v_xor_b32 v4, s65, v2
    v_lshl_add_u32 v13, v4, 4, v3
    v_bfe_u32 v2, v1, 2, 2
    v_lshl_add_u32 v3, v28, 3, v2
    v_lshlrev_b32 v3, 7, v3
    v_bfe_u32 v4, v1, 4, 1
    v_lshlrev_b32 v4, 1, v4
    v_bfe_u32 v5, v1, 1, 1
    v_or_b32 v4, v4, v5
    v_bfe_u32 v5, v1, 3, 1
    v_xor_b32 v5, s60, v5
    v_lshl_or_b32 v4, v5, 2, v4
    v_lshl_add_u32 v3, v4, 4, v3
    v_and_b32 v5, 1, v1
    v_lshl_add_u32 v3, v5, 3, v3
    s_xor_b32 s65, s69, 0
    s_lshl_b32 s65, s65, 11
    s_add_u32 s65, s65, 0x10000
    v_add_u32 v14, s65, v3
    v_add_u32 v18, 49152, v14
    s_xor_b32 s65, s69, 1
    s_lshl_b32 s65, s65, 11
    s_add_u32 s65, s65, 0x10000
    v_add_u32 v15, s65, v3
    v_add_u32 v19, 49152, v15
    s_xor_b32 s65, s69, 2
    s_lshl_b32 s65, s65, 11
    s_add_u32 s65, s65, 0x10000
    v_add_u32 v16, s65, v3
    v_add_u32 v20, 49152, v16
    s_xor_b32 s65, s69, 3
    s_lshl_b32 s65, s65, 11
    s_add_u32 s65, s65, 0x10000
    v_add_u32 v17, s65, v3
    v_add_u32 v21, 49152, v17
    v_mov_b32 v22, 0
    v_mov_b32 v23, 0
    v_mov_b32 v24, 0
    v_mov_b32 v25, 0
    v_bfe_u32 v2, v1, 4, 1
    v_bfe_u32 v3, v1, 2, 1
    v_cmp_eq_u32 vcc, v2, v3
    v_mov_b32 v2, s70
    s_nop 0
    v_cndmask_b32 v240, 0, v2, vcc
    v_cndmask_b32 v241, 0, v2, vcc
    v_cndmask_b32 v242, 0, v2, vcc
    v_cndmask_b32 v243, 0, v2, vcc
    s_lshl_b32 s64, s57, 2
    s_lshl_b32 s65, s60, 1
    s_add_u32 s77, s64, s65
    v_bfe_u32 v2, v1, 2, 1
    v_add_u32 v3, s77, v2
    v_lshlrev_b32 v3, 9, v3
    v_lshl_add_u32 v3, v28, 7, v3
    v_and_b32 v4, 24, v1
    v_add_u32 v3, v3, v4
    v_and_b32 v4, 3, v1
    v_lshl_add_u32 v3, v4, 1, v3
    buffer_load_ushort v116, v3, s[24:27], 0 offen offset:0
    buffer_load_ushort v117, v3, s[24:27], 0 offen offset:32
    buffer_load_ushort v118, v3, s[24:27], 0 offen offset:64
    buffer_load_ushort v119, v3, s[24:27], 0 offen offset:96
    buffer_load_ushort v120, v3, s[24:27], 0 offen offset:256
    buffer_load_ushort v121, v3, s[24:27], 0 offen offset:288
    buffer_load_ushort v122, v3, s[24:27], 0 offen offset:320
    buffer_load_ushort v123, v3, s[24:27], 0 offen offset:352
    v_and_b32 v3, 1, v1
    v_lshlrev_b32 v3, 4, v3
    v_mov_b32 v4, 0x3f80
    v_lshlrev_b32 v3, v3, v4
    v_bfe_u32 v4, v1, 4, 1
    v_cmp_eq_u32 vcc, v4, v28
    s_nop 1
    v_cndmask_b32 v3, 0, v3, vcc
    v_bfe_u32 v4, v1, 3, 1
    v_bfe_u32 v5, v1, 1, 1
    v_lshl_or_b32 v4, v4, 1, v5
    v_lshl_or_b32 v4, v2, 2, v4
    v_cmp_eq_u32 vcc, 0, v4
    s_nop 1
    v_cndmask_b32 v124, 0, v3, vcc
    v_cmp_eq_u32 vcc, 1, v4
    s_nop 1
    v_cndmask_b32 v125, 0, v3, vcc
    v_cmp_eq_u32 vcc, 2, v4
    s_nop 1
    v_cndmask_b32 v126, 0, v3, vcc
    v_cmp_eq_u32 vcc, 3, v4
    s_nop 1
    v_cndmask_b32 v127, 0, v3, vcc
    v_cmp_eq_u32 vcc, 4, v4
    s_nop 1
    v_cndmask_b32 v128, 0, v3, vcc
    v_cmp_eq_u32 vcc, 5, v4
    s_nop 1
    v_cndmask_b32 v129, 0, v3, vcc
    v_cmp_eq_u32 vcc, 6, v4
    s_nop 1
    v_cndmask_b32 v130, 0, v3, vcc
    v_cmp_eq_u32 vcc, 7, v4
    s_nop 1
    v_cndmask_b32 v131, 0, v3, vcc
    s_cmp_lt_u32 s2, 236
    s_cselect_b32 s26, 8192, 0
    s_sub_u32 s65, s2, 172
    s_cselect_b32 s24, s46, s38
    s_cselect_b32 s25, s47, s39
    s_cselect_b32 s64, s2, s65
    s_lshl_b32 s64, s64, 13
    s_add_u32 s24, s24, s64
    s_addc_u32 s25, s25, 0
    v_lshlrev_b32 v31, 4, v0
    buffer_load_dword v30, v31, s[24:27], 0 offen
    s_waitcnt vmcnt(14)
    s_barrier
    ds_read_b128 v[32:35], v10 offset:0
    ds_read_b64_tr_b16 v[36:37], v14 offset:0
    ds_read_b64_tr_b16 v[38:39], v14 offset:512
    ds_read_b64_tr_b16 v[40:41], v14 offset:8192
    ds_read_b64_tr_b16 v[42:43], v14 offset:8704
    ds_read_b64_tr_b16 v[44:45], v14 offset:16384
    ds_read_b64_tr_b16 v[46:47], v14 offset:16896
    s_add_u32 s74, s83, 2
    s_and_b32 s74, s74, 7
    s_lshl_b32 s71, s74, 7
    s_mul_i32 s72, s74, s61
    s_mul_i32 s73, s74, s62
    s_add_u32 m0, s66, 32768
    s_nop 0
    buffer_load_dwordx4 v6, s[4:7], s71 offen offset:0 lds
    s_add_u32 m0, s66, 32768
    s_nop 0
    buffer_load_dwordx4 v7, s[4:7], s71 offen offset:1024 lds
    s_waitcnt lgkmcnt(0)
    v_mfma_f32_32x32x16_bf16 v[64:79], v[36:39], v[32:35], 0
    ds_read_b128 v[48:51], v11 offset:0
    ds_read_b64_tr_b16 v[52:53], v15 offset:0
    ds_read_b64_tr_b16 v[54:55], v15 offset:512
    ds_read_b64_tr_b16 v[56:57], v15 offset:8192
    ds_read_b64_tr_b16 v[58:59], v15 offset:8704
    ds_read_b64_tr_b16 v[60:61], v15 offset:16384
    ds_read_b64_tr_b16 v[62:63], v15 offset:16896
    v_lshlrev_b32 v2, 16, v32
    v_and_b32 v3, 0xffff0000, v32
    v_add_f32 v22, v22, v2
    v_fmac_f32 v23, v2, v2
    v_mfma_f32_32x32x16_bf16 v[80:95], v[40:43], v[32:35], 0
    s_add_u32 m0, s67, 49152
    s_nop 0
    buffer_load_dwordx4 v8, s[8:11], s72 offen lds
    v_add_f32 v24, v24, v3
    v_fmac_f32 v25, v3, v3
    v_lshlrev_b32 v4, 16, v33
    v_and_b32 v5, 0xffff0000, v33
    v_mfma_f32_32x32x16_bf16 v[96:111], v[32:35], v[44:47], 0
    v_add_f32 v22, v22, v4
    v_fmac_f32 v23, v4, v4
    v_add_f32 v24, v24, v5
    v_fmac_f32 v25, v5, v5
    s_waitcnt lgkmcnt(0)
    v_mfma_f32_32x32x16_bf16 v[64:79], v[52:55], v[48:51], v[64:79]
    ds_read_b128 v[232:235], v12 offset:0
    ds_read_b64_tr_b16 v[36:37], v16 offset:0
    ds_read_b64_tr_b16 v[38:39], v16 offset:512
    ds_read_b64_tr_b16 v[40:41], v16 offset:8192
    ds_read_b64_tr_b16 v[42:43], v16 offset:8704
    ds_read_b64_tr_b16 v[44:45], v16 offset:16384
    ds_read_b64_tr_b16 v[46:47], v16 offset:16896
    v_lshlrev_b32 v2, 16, v34
    v_and_b32 v3, 0xffff0000, v34
    v_add_f32 v22, v22, v2
    v_fmac_f32 v23, v2, v2
    v_mfma_f32_16x16x32_bf16 v[244:247], v[240:243], v[52:55], 0
    v_mfma_f32_32x32x16_bf16 v[80:95], v[56:59], v[48:51], v[80:95]
    s_add_u32 m0, s67, 57344
    s_nop 0
    buffer_load_dwordx4 v9, s[12:15], s73 offen lds
    v_add_f32 v24, v24, v3
    v_fmac_f32 v25, v3, v3
    v_lshlrev_b32 v4, 16, v35
    v_and_b32 v5, 0xffff0000, v35
    v_mfma_f32_32x32x16_bf16 v[96:111], v[48:51], v[60:63], v[96:111]
    v_add_f32 v22, v22, v4
    v_fmac_f32 v23, v4, v4
    v_add_f32 v24, v24, v5
    v_fmac_f32 v25, v5, v5
    s_waitcnt lgkmcnt(0)
    v_mfma_f32_32x32x16_bf16 v[64:79], v[36:39], v[232:235], v[64:79]
    ds_read_b128 v[236:239], v13 offset:0
    ds_read_b64_tr_b16 v[52:53], v17 offset:0
    ds_read_b64_tr_b16 v[54:55], v17 offset:512
    ds_read_b64_tr_b16 v[56:57], v17 offset:8192
    ds_read_b64_tr_b16 v[58:59], v17 offset:8704
    ds_read_b64_tr_b16 v[60:61], v17 offset:16384
    ds_read_b64_tr_b16 v[62:63], v17 offset:16896
    v_lshlrev_b32 v2, 16, v48
    v_and_b32 v3, 0xffff0000, v48
    v_add_f32 v22, v22, v2
    v_fmac_f32 v23, v2, v2
    v_mfma_f32_32x32x16_bf16 v[80:95], v[40:43], v[232:235], v[80:95]
    s_add_u32 m0, s67, 65536
    s_nop 0
    buffer_load_dwordx4 v9, s[16:19], s73 offen lds
    v_add_f32 v24, v24, v3
    v_fmac_f32 v25, v3, v3
    v_lshlrev_b32 v4, 16, v49
    v_and_b32 v5, 0xffff0000, v49
    v_mfma_f32_32x32x16_bf16 v[96:111], v[232:235], v[44:47], v[96:111]
    v_add_f32 v22, v22, v4
    v_fmac_f32 v23, v4, v4
    v_add_f32 v24, v24, v5
    v_fmac_f32 v25, v5, v5
    v_mfma_f32_16x16x32_bf16 v[252:255], v[240:243], v[44:47], 0
    s_waitcnt lgkmcnt(0)
    v_mfma_f32_32x32x16_bf16 v[64:79], v[52:55], v[236:239], v[64:79]
    s_waitcnt vmcnt(14)
    s_barrier
    ds_read_b128 v[32:35], v10 offset:16384
    ds_read_b64_tr_b16 v[36:37], v14 offset:24576
    ds_read_b64_tr_b16 v[38:39], v14 offset:25088
    ds_read_b64_tr_b16 v[40:41], v14 offset:32768
    ds_read_b64_tr_b16 v[42:43], v14 offset:33280
    ds_read_b64_tr_b16 v[44:45], v14 offset:40960
    ds_read_b64_tr_b16 v[46:47], v14 offset:41472
    v_lshlrev_b32 v2, 16, v50
    v_and_b32 v3, 0xffff0000, v50
    v_add_f32 v22, v22, v2
    v_fmac_f32 v23, v2, v2
    v_mfma_f32_32x32x16_bf16 v[80:95], v[56:59], v[236:239], v[80:95]
    s_add_u32 s74, s83, 3
    s_and_b32 s74, s74, 7
    s_lshl_b32 s71, s74, 7
    s_mul_i32 s72, s74, s61
    s_mul_i32 s73, s74, s62
    s_add_u32 m0, s66, 49152
    s_nop 0
    buffer_load_dwordx4 v6, s[4:7], s71 offen offset:0 lds
    v_add_f32 v24, v24, v3
    v_fmac_f32 v25, v3, v3
    v_lshlrev_b32 v4, 16, v51
    v_and_b32 v5, 0xffff0000, v51
    v_mfma_f32_16x16x32_bf16 v[248:251], v[240:243], v[56:59], 0
    v_mfma_f32_32x32x16_bf16 v[96:111], v[236:239], v[60:63], v[96:111]
    s_add_u32 m0, s66, 49152
    s_nop 0
    buffer_load_dwordx4 v7, s[4:7], s71 offen offset:1024 lds
    v_add_f32 v22, v22, v4
    v_fmac_f32 v23, v4, v4
    v_add_f32 v24, v24, v5
    v_fmac_f32 v25, v5, v5
    s_waitcnt lgkmcnt(0)
    v_mfma_f32_32x32x16_bf16 v[64:79], v[36:39], v[32:35], v[64:79]
    ds_read_b128 v[48:51], v11 offset:16384
    ds_read_b64_tr_b16 v[52:53], v15 offset:24576
    ds_read_b64_tr_b16 v[54:55], v15 offset:25088
    ds_read_b64_tr_b16 v[56:57], v15 offset:32768
    ds_read_b64_tr_b16 v[58:59], v15 offset:33280
    ds_read_b64_tr_b16 v[60:61], v15 offset:40960
    ds_read_b64_tr_b16 v[62:63], v15 offset:41472
    v_lshlrev_b32 v2, 16, v32
    v_and_b32 v3, 0xffff0000, v32
    v_add_f32 v22, v22, v2
    v_fmac_f32 v23, v2, v2
    v_mfma_f32_32x32x16_bf16 v[80:95], v[40:43], v[32:35], v[80:95]
    s_add_u32 m0, s67, 73728
    s_nop 0
    buffer_load_dwordx4 v8, s[8:11], s72 offen lds
    v_add_f32 v24, v24, v3
    v_fmac_f32 v25, v3, v3
    v_lshlrev_b32 v4, 16, v33
    v_and_b32 v5, 0xffff0000, v33
    v_mfma_f32_32x32x16_bf16 v[96:111], v[32:35], v[44:47], v[96:111]
    v_add_f32 v22, v22, v4
    v_fmac_f32 v23, v4, v4
    v_add_f32 v24, v24, v5
    v_fmac_f32 v25, v5, v5
    s_waitcnt lgkmcnt(0)
    v_mfma_f32_32x32x16_bf16 v[64:79], v[52:55], v[48:51], v[64:79]
    ds_read_b128 v[232:235], v12 offset:16384
    ds_read_b64_tr_b16 v[36:37], v16 offset:24576
    ds_read_b64_tr_b16 v[38:39], v16 offset:25088
    ds_read_b64_tr_b16 v[40:41], v16 offset:32768
    ds_read_b64_tr_b16 v[42:43], v16 offset:33280
    ds_read_b64_tr_b16 v[44:45], v16 offset:40960
    ds_read_b64_tr_b16 v[46:47], v16 offset:41472
    v_lshlrev_b32 v2, 16, v34
    v_and_b32 v3, 0xffff0000, v34
    v_add_f32 v22, v22, v2
    v_fmac_f32 v23, v2, v2
    v_mfma_f32_16x16x32_bf16 v[244:247], v[240:243], v[52:55], v[244:247]
    v_mfma_f32_32x32x16_bf16 v[80:95], v[56:59], v[48:51], v[80:95]
    s_add_u32 m0, s67, 81920
    s_nop 0
    buffer_load_dwordx4 v9, s[12:15], s73 offen lds
    v_add_f32 v24, v24, v3
    v_fmac_f32 v25, v3, v3
    v_lshlrev_b32 v4, 16, v35
    v_and_b32 v5, 0xffff0000, v35
    v_mfma_f32_32x32x16_bf16 v[96:111], v[48:51], v[60:63], v[96:111]
    v_add_f32 v22, v22, v4
    v_fmac_f32 v23, v4, v4
    v_add_f32 v24, v24, v5
    v_fmac_f32 v25, v5, v5
    s_waitcnt lgkmcnt(0)
    v_mfma_f32_32x32x16_bf16 v[64:79], v[36:39], v[232:235], v[64:79]
    ds_read_b128 v[236:239], v13 offset:16384
    ds_read_b64_tr_b16 v[52:53], v17 offset:24576
    ds_read_b64_tr_b16 v[54:55], v17 offset:25088
    ds_read_b64_tr_b16 v[56:57], v17 offset:32768
    ds_read_b64_tr_b16 v[58:59], v17 offset:33280
    ds_read_b64_tr_b16 v[60:61], v17 offset:40960
    ds_read_b64_tr_b16 v[62:63], v17 offset:41472
    v_lshlrev_b32 v2, 16, v48
    v_and_b32 v3, 0xffff0000, v48
    v_add_f32 v22, v22, v2
    v_fmac_f32 v23, v2, v2
    v_mfma_f32_32x32x16_bf16 v[80:95], v[40:43], v[232:235], v[80:95]
    s_add_u32 m0, s67, 90112
    s_nop 0
    buffer_load_dwordx4 v9, s[16:19], s73 offen lds
    v_add_f32 v24, v24, v3
    v_fmac_f32 v25, v3, v3
    v_lshlrev_b32 v4, 16, v49
    v_and_b32 v5, 0xffff0000, v49
    v_mfma_f32_32x32x16_bf16 v[96:111], v[232:235], v[44:47], v[96:111]
    v_add_f32 v22, v22, v4
    v_fmac_f32 v23, v4, v4
    v_add_f32 v24, v24, v5
    v_fmac_f32 v25, v5, v5
    v_mfma_f32_16x16x32_bf16 v[252:255], v[240:243], v[44:47], v[252:255]
    s_waitcnt lgkmcnt(0)
    v_mfma_f32_32x32x16_bf16 v[64:79], v[52:55], v[236:239], v[64:79]
    s_waitcnt vmcnt(5)
    s_barrier
    s_cmp_lg_u32 s76, 0
    s_cbranch_scc1 K1_F1
    s_mov_b64 exec, 1
    buffer_store_dword v240, off, s[28:31], s75 sc1
    s_mov_b64 exec, -1
K1_F1:
    ds_read_b128 v[32:35], v10 offset:32768
    ds_read_b64_tr_b16 v[36:37], v18 offset:0
    ds_read_b64_tr_b16 v[38:39], v18 offset:512
    ds_read_b64_tr_b16 v[40:41], v18 offset:8192
    ds_read_b64_tr_b16 v[42:43], v18 offset:8704
    ds_read_b64_tr_b16 v[44:45], v18 offset:16384
    ds_read_b64_tr_b16 v[46:47], v18 offset:16896
    v_lshlrev_b32 v2, 16, v50
    v_and_b32 v3, 0xffff0000, v50
    v_add_f32 v22, v22, v2
    v_fmac_f32 v23, v2, v2
    v_mfma_f32_32x32x16_bf16 v[80:95], v[56:59], v[236:239], v[80:95]
    s_add_u32 s74, s83, 4
    s_and_b32 s74, s74, 7
    s_lshl_b32 s71, s74, 7
    s_mul_i32 s72, s74, s61
    s_mul_i32 s73, s74, s62
    s_add_u32 m0, s66, 0
    s_nop 0
    buffer_load_dwordx4 v6, s[4:7], s71 offen offset:0 lds
    v_add_f32 v24, v24, v3
    v_fmac_f32 v25, v3, v3
    v_lshlrev_b32 v4, 16, v51
    v_and_b32 v5, 0xffff0000, v51
    v_mfma_f32_16x16x32_bf16 v[248:251], v[240:243], v[56:59], v[248:251]
    v_mfma_f32_32x32x16_bf16 v[96:111], v[236:239], v[60:63], v[96:111]
    s_add_u32 m0, s66, 0
    s_nop 0
    buffer_load_dwordx4 v7, s[4:7], s71 offen offset:1024 lds
    v_add_f32 v22, v22, v4
    v_fmac_f32 v23, v4, v4
    v_add_f32 v24, v24, v5
    v_fmac_f32 v25, v5, v5
    s_waitcnt lgkmcnt(0)
    v_mfma_f32_32x32x16_bf16 v[64:79], v[36:39], v[32:35], v[64:79]
    ds_read_b128 v[48:51], v11 offset:32768
    ds_read_b64_tr_b16 v[52:53], v19 offset:0
    ds_read_b64_tr_b16 v[54:55], v19 offset:512
    ds_read_b64_tr_b16 v[56:57], v19 offset:8192
    ds_read_b64_tr_b16 v[58:59], v19 offset:8704
    ds_read_b64_tr_b16 v[60:61], v19 offset:16384
    ds_read_b64_tr_b16 v[62:63], v19 offset:16896
    v_lshlrev_b32 v2, 16, v32
    v_and_b32 v3, 0xffff0000, v32
    v_add_f32 v22, v22, v2
    v_fmac_f32 v23, v2, v2
    v_mfma_f32_32x32x16_bf16 v[80:95], v[40:43], v[32:35], v[80:95]
    s_add_u32 m0, s67, 0
    s_nop 0
    buffer_load_dwordx4 v8, s[8:11], s72 offen lds
    v_add_f32 v24, v24, v3
    v_fmac_f32 v25, v3, v3
    v_lshlrev_b32 v4, 16, v33
    v_and_b32 v5, 0xffff0000, v33
    v_mfma_f32_32x32x16_bf16 v[96:111], v[32:35], v[44:47], v[96:111]
    v_add_f32 v22, v22, v4
    v_fmac_f32 v23, v4, v4
    v_add_f32 v24, v24, v5
    v_fmac_f32 v25, v5, v5
    s_waitcnt lgkmcnt(0)
    v_mfma_f32_32x32x16_bf16 v[64:79], v[52:55], v[48:51], v[64:79]
    ds_read_b128 v[232:235], v12 offset:32768
    ds_read_b64_tr_b16 v[36:37], v20 offset:0
    ds_read_b64_tr_b16 v[38:39], v20 offset:512
    ds_read_b64_tr_b16 v[40:41], v20 offset:8192
    ds_read_b64_tr_b16 v[42:43], v20 offset:8704
    ds_read_b64_tr_b16 v[44:45], v20 offset:16384
    ds_read_b64_tr_b16 v[46:47], v20 offset:16896
    v_lshlrev_b32 v2, 16, v34
    v_and_b32 v3, 0xffff0000, v34
    v_add_f32 v22, v22, v2
    v_fmac_f32 v23, v2, v2
    v_mfma_f32_16x16x32_bf16 v[244:247], v[240:243], v[52:55], v[244:247]
    v_mfma_f32_32x32x16_bf16 v[80:95], v[56:59], v[48:51], v[80:95]
    s_add_u32 m0, s67, 8192
    s_nop 0
    buffer_load_dwordx4 v9, s[12:15], s73 offen lds
    v_add_f32 v24, v24, v3
    v_fmac_f32 v25, v3, v3
    v_lshlrev_b32 v4, 16, v35
    v_and_b32 v5, 0xffff0000, v35
    v_mfma_f32_32x32x16_bf16 v[96:111], v[48:51], v[60:63], v[96:111]
    v_add_f32 v22, v22, v4
    v_fmac_f32 v23, v4, v4
    v_add_f32 v24, v24, v5
    v_fmac_f32 v25, v5, v5
    s_waitcnt lgkmcnt(0)
    v_mfma_f32_32x32x16_bf16 v[64:79], v[36:39], v[232:235], v[64:79]
    ds_read_b128 v[236:239], v13 offset:32768
    ds_read_b64_tr_b16 v[52:53], v21 offset:0
    ds_read_b64_tr_b16 v[54:55], v21 offset:512
    ds_read_b64_tr_b16 v[56:57], v21 offset:8192
    ds_read_b64_tr_b16 v[58:59], v21 offset:8704
    ds_read_b64_tr_b16 v[60:61], v21 offset:16384
    ds_read_b64_tr_b16 v[62:63], v21 offset:16896
    v_lshlrev_b32 v2, 16, v48
    v_and_b32 v3, 0xffff0000, v48
    v_add_f32 v22, v22, v2
    v_fmac_f32 v23, v2, v2
    v_mfma_f32_32x32x16_bf16 v[80:95], v[40:43], v[232:235], v[80:95]
    s_add_u32 m0, s67, 16384
    s_nop 0
    buffer_load_dwordx4 v9, s[16:19], s73 offen lds
    v_add_f32 v24, v24, v3
    v_fmac_f32 v25, v3, v3
    v_lshlrev_b32 v4, 16, v49
    v_and_b32 v5, 0xffff0000, v49
    v_mfma_f32_32x32x16_bf16 v[96:111], v[232:235], v[44:47], v[96:111]
    v_add_f32 v22, v22, v4
    v_fmac_f32 v23, v4, v4
    v_add_f32 v24, v24, v5
    v_fmac_f32 v25, v5, v5
    v_mfma_f32_16x16x32_bf16 v[252:255], v[240:243], v[44:47], v[252:255]
    s_waitcnt lgkmcnt(0)
    v_mfma_f32_32x32x16_bf16 v[64:79], v[52:55], v[236:239], v[64:79]
    s_waitcnt vmcnt(5)
    s_barrier
    ds_read_b128 v[32:35], v10 offset:49152
    ds_read_b64_tr_b16 v[36:37], v18 offset:24576
    ds_read_b64_tr_b16 v[38:39], v18 offset:25088
    ds_read_b64_tr_b16 v[40:41], v18 offset:32768
    ds_read_b64_tr_b16 v[42:43], v18 offset:33280
    ds_read_b64_tr_b16 v[44:45], v18 offset:40960
    ds_read_b64_tr_b16 v[46:47], v18 offset:41472
    v_lshlrev_b32 v2, 16, v50
    v_and_b32 v3, 0xffff0000, v50
    v_add_f32 v22, v22, v2
    v_fmac_f32 v23, v2, v2
    v_mfma_f32_32x32x16_bf16 v[80:95], v[56:59], v[236:239], v[80:95]
    s_add_u32 s74, s83, 5
    s_and_b32 s74, s74, 7
    s_lshl_b32 s71, s74, 7
    s_mul_i32 s72, s74, s61
    s_mul_i32 s73, s74, s62
    s_add_u32 m0, s66, 16384
    s_nop 0
    buffer_load_dwordx4 v6, s[4:7], s71 offen offset:0 lds
    v_add_f32 v24, v24, v3
    v_fmac_f32 v25, v3, v3
    v_lshlrev_b32 v4, 16, v51
    v_and_b32 v5, 0xffff0000, v51
    v_mfma_f32_16x16x32_bf16 v[248:251], v[240:243], v[56:59], v[248:251]
    v_mfma_f32_32x32x16_bf16 v[96:111], v[236:239], v[60:63], v[96:111]
    s_add_u32 m0, s66, 16384
    s_nop 0
    buffer_load_dwordx4 v7, s[4:7], s71 offen offset:1024 lds
    v_add_f32 v22, v22, v4
    v_fmac_f32 v23, v4, v4
    v_add_f32 v24, v24, v5
    v_fmac_f32 v25, v5, v5
    s_waitcnt lgkmcnt(0)
    v_mfma_f32_32x32x16_bf16 v[64:79], v[36:39], v[32:35], v[64:79]
    ds_read_b128 v[48:51], v11 offset:49152
    ds_read_b64_tr_b16 v[52:53], v19 offset:24576
    ds_read_b64_tr_b16 v[54:55], v19 offset:25088
    ds_read_b64_tr_b16 v[56:57], v19 offset:32768
    ds_read_b64_tr_b16 v[58:59], v19 offset:33280
    ds_read_b64_tr_b16 v[60:61], v19 offset:40960
    ds_read_b64_tr_b16 v[62:63], v19 offset:41472
    v_lshlrev_b32 v2, 16, v32
    v_and_b32 v3, 0xffff0000, v32
    v_add_f32 v22, v22, v2
    v_fmac_f32 v23, v2, v2
    v_mfma_f32_32x32x16_bf16 v[80:95], v[40:43], v[32:35], v[80:95]
    s_add_u32 m0, s67, 24576
    s_nop 0
    buffer_load_dwordx4 v8, s[8:11], s72 offen lds
    v_add_f32 v24, v24, v3
    v_fmac_f32 v25, v3, v3
    v_lshlrev_b32 v4, 16, v33
    v_and_b32 v5, 0xffff0000, v33
    v_mfma_f32_32x32x16_bf16 v[96:111], v[32:35], v[44:47], v[96:111]
    v_add_f32 v22, v22, v4
    v_fmac_f32 v23, v4, v4
    v_add_f32 v24, v24, v5
    v_fmac_f32 v25, v5, v5
    s_waitcnt lgkmcnt(0)
    v_mfma_f32_32x32x16_bf16 v[64:79], v[52:55], v[48:51], v[64:79]
    ds_read_b128 v[232:235], v12 offset:49152
    ds_read_b64_tr_b16 v[36:37], v20 offset:24576
    ds_read_b64_tr_b16 v[38:39], v20 offset:25088
    ds_read_b64_tr_b16 v[40:41], v20 offset:32768
    ds_read_b64_tr_b16 v[42:43], v20 offset:33280
    ds_read_b64_tr_b16 v[44:45], v20 offset:40960
    ds_read_b64_tr_b16 v[46:47], v20 offset:41472
    v_lshlrev_b32 v2, 16, v34
    v_and_b32 v3, 0xffff0000, v34
    v_add_f32 v22, v22, v2
    v_fmac_f32 v23, v2, v2
    v_mfma_f32_16x16x32_bf16 v[244:247], v[240:243], v[52:55], v[244:247]
    v_mfma_f32_32x32x16_bf16 v[80:95], v[56:59], v[48:51], v[80:95]
    s_add_u32 m0, s67, 32768
    s_nop 0
    buffer_load_dwordx4 v9, s[12:15], s73 offen lds
    v_add_f32 v24, v24, v3
    v_fmac_f32 v25, v3, v3
    v_lshlrev_b32 v4, 16, v35
    v_and_b32 v5, 0xffff0000, v35
    v_mfma_f32_32x32x16_bf16 v[96:111], v[48:51], v[60:63], v[96:111]
    v_add_f32 v22, v22, v4
    v_fmac_f32 v23, v4, v4
    v_add_f32 v24, v24, v5
    v_fmac_f32 v25, v5, v5
    s_waitcnt lgkmcnt(0)
    v_mfma_f32_32x32x16_bf16 v[64:79], v[36:39], v[232:235], v[64:79]
    ds_read_b128 v[236:239], v13 offset:49152
    ds_read_b64_tr_b16 v[52:53], v21 offset:24576
    ds_read_b64_tr_b16 v[54:55], v21 offset:25088
    ds_read_b64_tr_b16 v[56:57], v21 offset:32768
    ds_read_b64_tr_b16 v[58:59], v21 offset:33280
    ds_read_b64_tr_b16 v[60:61], v21 offset:40960
    ds_read_b64_tr_b16 v[62:63], v21 offset:41472
    v_lshlrev_b32 v2, 16, v48
    v_and_b32 v3, 0xffff0000, v48
    v_add_f32 v22, v22, v2
    v_fmac_f32 v23, v2, v2
    v_mfma_f32_32x32x16_bf16 v[80:95], v[40:43], v[232:235], v[80:95]
    s_add_u32 m0, s67, 40960
    s_nop 0
    buffer_load_dwordx4 v9, s[16:19], s73 offen lds
    v_add_f32 v24, v24, v3
    v_fmac_f32 v25, v3, v3
    v_lshlrev_b32 v4, 16, v49
    v_and_b32 v5, 0xffff0000, v49
    v_mfma_f32_32x32x16_bf16 v[96:111], v[232:235], v[44:47], v[96:111]
    v_add_f32 v22, v22, v4
    v_fmac_f32 v23, v4, v4
    v_add_f32 v24, v24, v5
    v_fmac_f32 v25, v5, v5
    v_mfma_f32_16x16x32_bf16 v[252:255], v[240:243], v[44:47], v[252:255]
    s_waitcnt lgkmcnt(0)
    v_mfma_f32_32x32x16_bf16 v[64:79], v[52:55], v[236:239], v[64:79]
    s_waitcnt vmcnt(5)
    s_barrier
    ds_read_b128 v[32:35], v10 offset:0
    ds_read_b64_tr_b16 v[36:37], v14 offset:0
    ds_read_b64_tr_b16 v[38:39], v14 offset:512
    ds_read_b64_tr_b16 v[40:41], v14 offset:8192
    ds_read_b64_tr_b16 v[42:43], v14 offset:8704
    ds_read_b64_tr_b16 v[44:45], v14 offset:16384
    ds_read_b64_tr_b16 v[46:47], v14 offset:16896
    v_lshlrev_b32 v2, 16, v50
    v_and_b32 v3, 0xffff0000, v50
    v_add_f32 v22, v22, v2
    v_fmac_f32 v23, v2, v2
    v_mfma_f32_32x32x16_bf16 v[80:95], v[56:59], v[236:239], v[80:95]
    s_add_u32 s74, s83, 6
    s_and_b32 s74, s74, 7
    s_lshl_b32 s71, s74, 7
    s_mul_i32 s72, s74, s61
    s_mul_i32 s73, s74, s62
    s_add_u32 m0, s66, 32768
    s_nop 0
    buffer_load_dwordx4 v6, s[4:7], s71 offen offset:0 lds
    v_add_f32 v24, v24, v3
    v_fmac_f32 v25, v3, v3
    v_lshlrev_b32 v4, 16, v51
    v_and_b32 v5, 0xffff0000, v51
    v_mfma_f32_16x16x32_bf16 v[248:251], v[240:243], v[56:59], v[248:251]
    v_mfma_f32_32x32x16_bf16 v[96:111], v[236:239], v[60:63], v[96:111]
    s_add_u32 m0, s66, 32768
    s_nop 0
    buffer_load_dwordx4 v7, s[4:7], s71 offen offset:1024 lds
    v_add_f32 v22, v22, v4
    v_fmac_f32 v23, v4, v4
    v_add_f32 v24, v24, v5
    v_fmac_f32 v25, v5, v5
    s_lshr_b32 s64, s2, 3
    s_min_u32 s64, s64, 29
    s_sub_u32 s65, s64, 22
    s_cselect_b32 s24, s46, s38
    s_cselect_b32 s25, s47, s39
    s_mov_b32 s26, 524288
    s_cselect_b32 s26, 1409024, s26
    s_cselect_b32 s64, s64, s65
    s_lshl_b32 s64, s64, 16
    s_add_u32 s64, s64, 384
    buffer_load_dword v30, v26, s[24:27], s64 offen
    s_waitcnt lgkmcnt(0)
    v_mfma_f32_32x32x16_bf16 v[64:79], v[36:39], v[32:35], v[64:79]
    ds_read_b128 v[48:51], v11 offset:0
    ds_read_b64_tr_b16 v[52:53], v15 offset:0
    ds_read_b64_tr_b16 v[54:55], v15 offset:512
    ds_read_b64_tr_b16 v[56:57], v15 offset:8192
    ds_read_b64_tr_b16 v[58:59], v15 offset:8704
    ds_read_b64_tr_b16 v[60:61], v15 offset:16384
    ds_read_b64_tr_b16 v[62:63], v15 offset:16896
    v_lshlrev_b32 v2, 16, v32
    v_and_b32 v3, 0xffff0000, v32
    v_add_f32 v22, v22, v2
    v_fmac_f32 v23, v2, v2
    v_mfma_f32_32x32x16_bf16 v[80:95], v[40:43], v[32:35], v[80:95]
    s_add_u32 m0, s67, 49152
    s_nop 0
    buffer_load_dwordx4 v8, s[8:11], s72 offen lds
    v_add_f32 v24, v24, v3
    v_fmac_f32 v25, v3, v3
    v_lshlrev_b32 v4, 16, v33
    v_and_b32 v5, 0xffff0000, v33
    v_mfma_f32_32x32x16_bf16 v[96:111], v[32:35], v[44:47], v[96:111]
    v_add_f32 v22, v22, v4
    v_fmac_f32 v23, v4, v4
    v_add_f32 v24, v24, v5
    v_fmac_f32 v25, v5, v5
    s_waitcnt lgkmcnt(0)
    v_mfma_f32_32x32x16_bf16 v[64:79], v[52:55], v[48:51], v[64:79]
    ds_read_b128 v[232:235], v12 offset:0
    ds_read_b64_tr_b16 v[36:37], v16 offset:0
    ds_read_b64_tr_b16 v[38:39], v16 offset:512
    ds_read_b64_tr_b16 v[40:41], v16 offset:8192
    ds_read_b64_tr_b16 v[42:43], v16 offset:8704
    ds_read_b64_tr_b16 v[44:45], v16 offset:16384
    ds_read_b64_tr_b16 v[46:47], v16 offset:16896
    v_lshlrev_b32 v2, 16, v34
    v_and_b32 v3, 0xffff0000, v34
    v_add_f32 v22, v22, v2
    v_fmac_f32 v23, v2, v2
    v_mfma_f32_16x16x32_bf16 v[244:247], v[240:243], v[52:55], v[244:247]
    v_mfma_f32_32x32x16_bf16 v[80:95], v[56:59], v[48:51], v[80:95]
    s_add_u32 m0, s67, 57344
    s_nop 0
    buffer_load_dwordx4 v9, s[12:15], s73 offen lds
    v_add_f32 v24, v24, v3
    v_fmac_f32 v25, v3, v3
    v_lshlrev_b32 v4, 16, v35
    v_and_b32 v5, 0xffff0000, v35
    v_mfma_f32_32x32x16_bf16 v[96:111], v[48:51], v[60:63], v[96:111]
    v_add_f32 v22, v22, v4
    v_fmac_f32 v23, v4, v4
    v_add_f32 v24, v24, v5
    v_fmac_f32 v25, v5, v5
    s_waitcnt lgkmcnt(0)
    v_mfma_f32_32x32x16_bf16 v[64:79], v[36:39], v[232:235], v[64:79]
    ds_read_b128 v[236:239], v13 offset:0
    ds_read_b64_tr_b16 v[52:53], v17 offset:0
    ds_read_b64_tr_b16 v[54:55], v17 offset:512
    ds_read_b64_tr_b16 v[56:57], v17 offset:8192
    ds_read_b64_tr_b16 v[58:59], v17 offset:8704
    ds_read_b64_tr_b16 v[60:61], v17 offset:16384
    ds_read_b64_tr_b16 v[62:63], v17 offset:16896
    v_lshlrev_b32 v2, 16, v48
    v_and_b32 v3, 0xffff0000, v48
    v_add_f32 v22, v22, v2
    v_fmac_f32 v23, v2, v2
    v_mfma_f32_32x32x16_bf16 v[80:95], v[40:43], v[232:235], v[80:95]
    s_add_u32 m0, s67, 65536
    s_nop 0
    buffer_load_dwordx4 v9, s[16:19], s73 offen lds
    v_add_f32 v24, v24, v3
    v_fmac_f32 v25, v3, v3
    v_lshlrev_b32 v4, 16, v49
    v_and_b32 v5, 0xffff0000, v49
    v_mfma_f32_32x32x16_bf16 v[96:111], v[232:235], v[44:47], v[96:111]
    v_add_f32 v22, v22, v4
    v_fmac_f32 v23, v4, v4
    v_add_f32 v24, v24, v5
    v_fmac_f32 v25, v5, v5
    v_mfma_f32_16x16x32_bf16 v[252:255], v[240:243], v[44:47], v[252:255]
    s_waitcnt lgkmcnt(0)
    v_mfma_f32_32x32x16_bf16 v[64:79], v[52:55], v[236:239], v[64:79]
    s_waitcnt vmcnt(6)
    s_barrier
    ds_read_b128 v[32:35], v10 offset:16384
    ds_read_b64_tr_b16 v[36:37], v14 offset:24576
    ds_read_b64_tr_b16 v[38:39], v14 offset:25088
    ds_read_b64_tr_b16 v[40:41], v14 offset:32768
    ds_read_b64_tr_b16 v[42:43], v14 offset:33280
    ds_read_b64_tr_b16 v[44:45], v14 offset:40960
    ds_read_b64_tr_b16 v[46:47], v14 offset:41472
    v_lshlrev_b32 v2, 16, v50
    v_and_b32 v3, 0xffff0000, v50
    v_add_f32 v22, v22, v2
    v_fmac_f32 v23, v2, v2
    v_mfma_f32_32x32x16_bf16 v[80:95], v[56:59], v[236:239], v[80:95]
    s_add_u32 s74, s83, 7
    s_and_b32 s74, s74, 7
    s_lshl_b32 s71, s74, 7
    s_mul_i32 s72, s74, s61
    s_mul_i32 s73, s74, s62
    s_add_u32 m0, s66, 49152
    s_nop 0
    buffer_load_dwordx4 v6, s[4:7], s71 offen offset:0 lds
    v_add_f32 v24, v24, v3
    v_fmac_f32 v25, v3, v3
    v_lshlrev_b32 v4, 16, v51
    v_and_b32 v5, 0xffff0000, v51
    v_mfma_f32_16x16x32_bf16 v[248:251], v[240:243], v[56:59], v[248:251]
    v_mfma_f32_32x32x16_bf16 v[96:111], v[236:239], v[60:63], v[96:111]
    s_add_u32 m0, s66, 49152
    s_nop 0
    buffer_load_dwordx4 v7, s[4:7], s71 offen offset:1024 lds
    v_add_f32 v22, v22, v4
    v_fmac_f32 v23, v4, v4
    v_add_f32 v24, v24, v5
    v_fmac_f32 v25, v5, v5
    s_waitcnt lgkmcnt(0)
    v_mfma_f32_32x32x16_bf16 v[64:79], v[36:39], v[32:35], v[64:79]
    ds_read_b128 v[48:51], v11 offset:16384
    ds_read_b64_tr_b16 v[52:53], v15 offset:24576
    ds_read_b64_tr_b16 v[54:55], v15 offset:25088
    ds_read_b64_tr_b16 v[56:57], v15 offset:32768
    ds_read_b64_tr_b16 v[58:59], v15 offset:33280
    ds_read_b64_tr_b16 v[60:61], v15 offset:40960
    ds_read_b64_tr_b16 v[62:63], v15 offset:41472
    v_lshlrev_b32 v2, 16, v32
    v_and_b32 v3, 0xffff0000, v32
    v_add_f32 v22, v22, v2
    v_fmac_f32 v23, v2, v2
    v_mfma_f32_32x32x16_bf16 v[80:95], v[40:43], v[32:35], v[80:95]
    s_add_u32 m0, s67, 73728
    s_nop 0
    buffer_load_dwordx4 v8, s[8:11], s72 offen lds
    v_add_f32 v24, v24, v3
    v_fmac_f32 v25, v3, v3
    v_lshlrev_b32 v4, 16, v33
    v_and_b32 v5, 0xffff0000, v33
    v_mfma_f32_32x32x16_bf16 v[96:111], v[32:35], v[44:47], v[96:111]
    v_add_f32 v22, v22, v4
    v_fmac_f32 v23, v4, v4
    v_add_f32 v24, v24, v5
    v_fmac_f32 v25, v5, v5
    s_waitcnt lgkmcnt(0)
    v_mfma_f32_32x32x16_bf16 v[64:79], v[52:55], v[48:51], v[64:79]
    ds_read_b128 v[232:235], v12 offset:16384
    ds_read_b64_tr_b16 v[36:37], v16 offset:24576
    ds_read_b64_tr_b16 v[38:39], v16 offset:25088
    ds_read_b64_tr_b16 v[40:41], v16 offset:32768
    ds_read_b64_tr_b16 v[42:43], v16 offset:33280
    ds_read_b64_tr_b16 v[44:45], v16 offset:40960
    ds_read_b64_tr_b16 v[46:47], v16 offset:41472
    v_lshlrev_b32 v2, 16, v34
    v_and_b32 v3, 0xffff0000, v34
    v_add_f32 v22, v22, v2
    v_fmac_f32 v23, v2, v2
    v_mfma_f32_16x16x32_bf16 v[244:247], v[240:243], v[52:55], v[244:247]
    v_mfma_f32_32x32x16_bf16 v[80:95], v[56:59], v[48:51], v[80:95]
    s_add_u32 m0, s67, 81920
    s_nop 0
    buffer_load_dwordx4 v9, s[12:15], s73 offen lds
    v_add_f32 v24, v24, v3
    v_fmac_f32 v25, v3, v3
    v_lshlrev_b32 v4, 16, v35
    v_and_b32 v5, 0xffff0000, v35
    v_mfma_f32_32x32x16_bf16 v[96:111], v[48:51], v[60:63], v[96:111]
    v_add_f32 v22, v22, v4
    v_fmac_f32 v23, v4, v4
    v_add_f32 v24, v24, v5
    v_fmac_f32 v25, v5, v5
    s_waitcnt lgkmcnt(0)
    v_mfma_f32_32x32x16_bf16 v[64:79], v[36:39], v[232:235], v[64:79]
    ds_read_b128 v[236:239], v13 offset:16384
    ds_read_b64_tr_b16 v[52:53], v17 offset:24576
    ds_read_b64_tr_b16 v[54:55], v17 offset:25088
    ds_read_b64_tr_b16 v[56:57], v17 offset:32768
    ds_read_b64_tr_b16 v[58:59], v17 offset:33280
    ds_read_b64_tr_b16 v[60:61], v17 offset:40960
    ds_read_b64_tr_b16 v[62:63], v17 offset:41472
    v_lshlrev_b32 v2, 16, v48
    v_and_b32 v3, 0xffff0000, v48
    v_add_f32 v22, v22, v2
    v_fmac_f32 v23, v2, v2
    v_mfma_f32_32x32x16_bf16 v[80:95], v[40:43], v[232:235], v[80:95]
    s_add_u32 m0, s67, 90112
    s_nop 0
    buffer_load_dwordx4 v9, s[16:19], s73 offen lds
    v_add_f32 v24, v24, v3
    v_fmac_f32 v25, v3, v3
    v_lshlrev_b32 v4, 16, v49
    v_and_b32 v5, 0xffff0000, v49
    v_mfma_f32_32x32x16_bf16 v[96:111], v[232:235], v[44:47], v[96:111]
    v_add_f32 v22, v22, v4
    v_fmac_f32 v23, v4, v4
    v_add_f32 v24, v24, v5
    v_fmac_f32 v25, v5, v5
    v_mfma_f32_16x16x32_bf16 v[252:255], v[240:243], v[44:47], v[252:255]
    s_waitcnt lgkmcnt(0)
    v_mfma_f32_32x32x16_bf16 v[64:79], v[52:55], v[236:239], v[64:79]
    s_waitcnt vmcnt(5)
    s_barrier
    ds_read_b128 v[32:35], v10 offset:32768
    ds_read_b64_tr_b16 v[36:37], v18 offset:0
    ds_read_b64_tr_b16 v[38:39], v18 offset:512
    ds_read_b64_tr_b16 v[40:41], v18 offset:8192
    ds_read_b64_tr_b16 v[42:43], v18 offset:8704
    ds_read_b64_tr_b16 v[44:45], v18 offset:16384
    ds_read_b64_tr_b16 v[46:47], v18 offset:16896
    v_lshlrev_b32 v2, 16, v50
    v_and_b32 v3, 0xffff0000, v50
    v_add_f32 v22, v22, v2
    v_fmac_f32 v23, v2, v2
    v_mfma_f32_32x32x16_bf16 v[80:95], v[56:59], v[236:239], v[80:95]
    v_add_f32 v24, v24, v3
    v_fmac_f32 v25, v3, v3
    v_lshlrev_b32 v4, 16, v51
    v_and_b32 v5, 0xffff0000, v51
    v_mfma_f32_16x16x32_bf16 v[248:251], v[240:243], v[56:59], v[248:251]
    v_mfma_f32_32x32x16_bf16 v[96:111], v[236:239], v[60:63], v[96:111]
    v_add_f32 v22, v22, v4
    v_fmac_f32 v23, v4, v4
    v_add_f32 v24, v24, v5
    v_fmac_f32 v25, v5, v5
    s_waitcnt lgkmcnt(0)
    v_mfma_f32_32x32x16_bf16 v[64:79], v[36:39], v[32:35], v[64:79]
    ds_read_b128 v[48:51], v11 offset:32768
    ds_read_b64_tr_b16 v[52:53], v19 offset:0
    ds_read_b64_tr_b16 v[54:55], v19 offset:512
    ds_read_b64_tr_b16 v[56:57], v19 offset:8192
    ds_read_b64_tr_b16 v[58:59], v19 offset:8704
    ds_read_b64_tr_b16 v[60:61], v19 offset:16384
    ds_read_b64_tr_b16 v[62:63], v19 offset:16896
    v_lshlrev_b32 v2, 16, v32
    v_and_b32 v3, 0xffff0000, v32
    v_add_f32 v22, v22, v2
    v_fmac_f32 v23, v2, v2
    v_mfma_f32_32x32x16_bf16 v[80:95], v[40:43], v[32:35], v[80:95]
    v_add_f32 v24, v24, v3
    v_fmac_f32 v25, v3, v3
    v_lshlrev_b32 v4, 16, v33
    v_and_b32 v5, 0xffff0000, v33
    v_mfma_f32_32x32x16_bf16 v[96:111], v[32:35], v[44:47], v[96:111]
    v_add_f32 v22, v22, v4
    v_fmac_f32 v23, v4, v4
    v_add_f32 v24, v24, v5
    v_fmac_f32 v25, v5, v5
    s_waitcnt lgkmcnt(0)
    v_mfma_f32_32x32x16_bf16 v[64:79], v[52:55], v[48:51], v[64:79]
    ds_read_b128 v[232:235], v12 offset:32768
    ds_read_b64_tr_b16 v[36:37], v20 offset:0
    ds_read_b64_tr_b16 v[38:39], v20 offset:512
    ds_read_b64_tr_b16 v[40:41], v20 offset:8192
    ds_read_b64_tr_b16 v[42:43], v20 offset:8704
    ds_read_b64_tr_b16 v[44:45], v20 offset:16384
    ds_read_b64_tr_b16 v[46:47], v20 offset:16896
    v_lshlrev_b32 v2, 16, v34
    v_and_b32 v3, 0xffff0000, v34
    v_add_f32 v22, v22, v2
    v_fmac_f32 v23, v2, v2
    v_mfma_f32_16x16x32_bf16 v[244:247], v[240:243], v[52:55], v[244:247]
    v_mfma_f32_32x32x16_bf16 v[80:95], v[56:59], v[48:51], v[80:95]
    v_add_f32 v24, v24, v3
    v_fmac_f32 v25, v3, v3
    v_lshlrev_b32 v4, 16, v35
    v_and_b32 v5, 0xffff0000, v35
    v_mfma_f32_32x32x16_bf16 v[96:111], v[48:51], v[60:63], v[96:111]
    v_add_f32 v22, v22, v4
    v_fmac_f32 v23, v4, v4
    v_add_f32 v24, v24, v5
    v_fmac_f32 v25, v5, v5
    s_waitcnt lgkmcnt(0)
    v_mfma_f32_32x32x16_bf16 v[64:79], v[36:39], v[232:235], v[64:79]
    ds_read_b128 v[236:239], v13 offset:32768
    ds_read_b64_tr_b16 v[52:53], v21 offset:0
    ds_read_b64_tr_b16 v[54:55], v21 offset:512
    ds_read_b64_tr_b16 v[56:57], v21 offset:8192
    ds_read_b64_tr_b16 v[58:59], v21 offset:8704
    ds_read_b64_tr_b16 v[60:61], v21 offset:16384
    ds_read_b64_tr_b16 v[62:63], v21 offset:16896
    v_lshlrev_b32 v2, 16, v48
    v_and_b32 v3, 0xffff0000, v48
    v_add_f32 v22, v22, v2
    v_fmac_f32 v23, v2, v2
    v_mfma_f32_32x32x16_bf16 v[80:95], v[40:43], v[232:235], v[80:95]
    v_add_f32 v24, v24, v3
    v_fmac_f32 v25, v3, v3
    v_lshlrev_b32 v4, 16, v49
    v_and_b32 v5, 0xffff0000, v49
    v_mfma_f32_32x32x16_bf16 v[96:111], v[232:235], v[44:47], v[96:111]
    v_add_f32 v22, v22, v4
    v_fmac_f32 v23, v4, v4
    v_add_f32 v24, v24, v5
    v_fmac_f32 v25, v5, v5
    v_mfma_f32_16x16x32_bf16 v[252:255], v[240:243], v[44:47], v[252:255]
    s_waitcnt lgkmcnt(0)
    v_mfma_f32_32x32x16_bf16 v[64:79], v[52:55], v[236:239], v[64:79]
    s_waitcnt vmcnt(0)
    s_barrier
    ds_read_b128 v[32:35], v10 offset:49152
    ds_read_b64_tr_b16 v[36:37], v18 offset:24576
    ds_read_b64_tr_b16 v[38:39], v18 offset:25088
    ds_read_b64_tr_b16 v[40:41], v18 offset:32768
    ds_read_b64_tr_b16 v[42:43], v18 offset:33280
    ds_read_b64_tr_b16 v[44:45], v18 offset:40960
    ds_read_b64_tr_b16 v[46:47], v18 offset:41472
    v_lshlrev_b32 v2, 16, v50
    v_and_b32 v3, 0xffff0000, v50
    v_add_f32 v22, v22, v2
    v_fmac_f32 v23, v2, v2
    v_mfma_f32_32x32x16_bf16 v[80:95], v[56:59], v[236:239], v[80:95]
    v_add_f32 v24, v24, v3
    v_fmac_f32 v25, v3, v3
    v_lshlrev_b32 v4, 16, v51
    v_and_b32 v5, 0xffff0000, v51
    v_mfma_f32_16x16x32_bf16 v[248:251], v[240:243], v[56:59], v[248:251]
    v_mfma_f32_32x32x16_bf16 v[96:111], v[236:239], v[60:63], v[96:111]
    v_add_f32 v22, v22, v4
    v_fmac_f32 v23, v4, v4
    v_add_f32 v24, v24, v5
    v_fmac_f32 v25, v5, v5
    s_waitcnt lgkmcnt(0)
    v_mfma_f32_32x32x16_bf16 v[64:79], v[36:39], v[32:35], v[64:79]
    ds_read_b128 v[48:51], v11 offset:49152
    ds_read_b64_tr_b16 v[52:53], v19 offset:24576
    ds_read_b64_tr_b16 v[54:55], v19 offset:25088
    ds_read_b64_tr_b16 v[56:57], v19 offset:32768
    ds_read_b64_tr_b16 v[58:59], v19 offset:33280
    ds_read_b64_tr_b16 v[60:61], v19 offset:40960
    ds_read_b64_tr_b16 v[62:63], v19 offset:41472
    v_lshlrev_b32 v2, 16, v32
    v_and_b32 v3, 0xffff0000, v32
    v_add_f32 v22, v22, v2
    v_fmac_f32 v23, v2, v2
    v_mfma_f32_32x32x16_bf16 v[80:95], v[40:43], v[32:35], v[80:95]
    v_add_f32 v24, v24, v3
    v_fmac_f32 v25, v3, v3
    v_lshlrev_b32 v4, 16, v33
    v_and_b32 v5, 0xffff0000, v33
    v_mfma_f32_32x32x16_bf16 v[96:111], v[32:35], v[44:47], v[96:111]
    v_add_f32 v22, v22, v4
    v_fmac_f32 v23, v4, v4
    v_add_f32 v24, v24, v5
    v_fmac_f32 v25, v5, v5
    s_waitcnt lgkmcnt(0)
    v_mfma_f32_32x32x16_bf16 v[64:79], v[52:55], v[48:51], v[64:79]
    ds_read_b128 v[232:235], v12 offset:49152
    ds_read_b64_tr_b16 v[36:37], v20 offset:24576
    ds_read_b64_tr_b16 v[38:39], v20 offset:25088
    ds_read_b64_tr_b16 v[40:41], v20 offset:32768
    ds_read_b64_tr_b16 v[42:43], v20 offset:33280
    ds_read_b64_tr_b16 v[44:45], v20 offset:40960
    ds_read_b64_tr_b16 v[46:47], v20 offset:41472
    v_lshlrev_b32 v2, 16, v34
    v_and_b32 v3, 0xffff0000, v34
    v_add_f32 v22, v22, v2
    v_fmac_f32 v23, v2, v2
    v_mfma_f32_16x16x32_bf16 v[244:247], v[240:243], v[52:55], v[244:247]
    v_mfma_f32_32x32x16_bf16 v[80:95], v[56:59], v[48:51], v[80:95]
    v_add_f32 v24, v24, v3
    v_fmac_f32 v25, v3, v3
    v_lshlrev_b32 v4, 16, v35
    v_and_b32 v5, 0xffff0000, v35
    v_mfma_f32_32x32x16_bf16 v[96:111], v[48:51], v[60:63], v[96:111]
    v_add_f32 v22, v22, v4
    v_fmac_f32 v23, v4, v4
    v_add_f32 v24, v24, v5
    v_fmac_f32 v25, v5, v5
    s_waitcnt lgkmcnt(0)
    v_mfma_f32_32x32x16_bf16 v[64:79], v[36:39], v[232:235], v[64:79]
    ds_read_b128 v[236:239], v13 offset:49152
    ds_read_b64_tr_b16 v[52:53], v21 offset:24576
    ds_read_b64_tr_b16 v[54:55], v21 offset:25088
    ds_read_b64_tr_b16 v[56:57], v21 offset:32768
    ds_read_b64_tr_b16 v[58:59], v21 offset:33280
    ds_read_b64_tr_b16 v[60:61], v21 offset:40960
    ds_read_b64_tr_b16 v[62:63], v21 offset:41472
    v_lshlrev_b32 v2, 16, v48
    v_and_b32 v3, 0xffff0000, v48
    v_add_f32 v22, v22, v2
    v_fmac_f32 v23, v2, v2
    v_mfma_f32_32x32x16_bf16 v[80:95], v[40:43], v[232:235], v[80:95]
    v_add_f32 v24, v24, v3
    v_fmac_f32 v25, v3, v3
    v_lshlrev_b32 v4, 16, v49
    v_and_b32 v5, 0xffff0000, v49
    v_mfma_f32_32x32x16_bf16 v[96:111], v[232:235], v[44:47], v[96:111]
    v_add_f32 v22, v22, v4
    v_fmac_f32 v23, v4, v4
    v_add_f32 v24, v24, v5
    v_fmac_f32 v25, v5, v5
    v_mfma_f32_16x16x32_bf16 v[252:255], v[240:243], v[44:47], v[252:255]
    s_waitcnt lgkmcnt(0)
    v_mfma_f32_32x32x16_bf16 v[64:79], v[52:55], v[236:239], v[64:79]
    v_lshlrev_b32 v2, 16, v50
    v_and_b32 v3, 0xffff0000, v50
    v_add_f32 v22, v22, v2
    v_fmac_f32 v23, v2, v2
    v_mfma_f32_32x32x16_bf16 v[80:95], v[56:59], v[236:239], v[80:95]
    v_add_f32 v24, v24, v3
    v_fmac_f32 v25, v3, v3
    v_lshlrev_b32 v4, 16, v51
    v_and_b32 v5, 0xffff0000, v51
    v_mfma_f32_16x16x32_bf16 v[248:251], v[240:243], v[56:59], v[248:251]
    v_mfma_f32_32x32x16_bf16 v[96:111], v[236:239], v[60:63], v[96:111]
    v_add_f32 v22, v22, v4
    v_fmac_f32 v23, v4, v4
    v_add_f32 v24, v24, v5
    v_fmac_f32 v25, v5, v5
    v_lshlrev_b32 v30, 2, v1
    buffer_load_dword v30, v30, s[28:31], 0 offen sc1
    v_add_f32 v22, v22, v24
    v_add_f32 v23, v23, v25
    s_lshl_b32 s65, s59, 9
    s_lshl_b32 s64, s60, 8
    s_add_u32 s64, s64, s65
    v_lshlrev_b32 v3, 2, v1
    v_permlane32_swap_b32 v22, v23
    v_add_u32 v3, s64, v3
    s_mul_i32 s64, s60, 1536
    s_lshl_b32 s63, s59, 2
    s_add_u32 s63, s63, s64
    v_add_f32 v22, v22, v23
    v_lshl_add_u32 v5, v29, 4, s63
    ds_write_b32 v3, v22 offset:36864
    ds_write_b32 v5, v244 offset:38912
    ds_write_b32 v5, v252 offset:39936
    ds_write_b32 v5, v248 offset:39424
    s_waitcnt lgkmcnt(0)
    s_barrier
    s_add_u32 s65, s65, 36864
    v_lshl_add_u32 v3, v29, 2, s65
    v_lshl_add_u32 v4, v29, 4, s64
    ds_read2_b32 v[132:133], v3 offset0:0 offset1:64
    ds_read2_b32 v[134:135], v3 offset0:32 offset1:96
    ds_read_b128 v[136:139], v4 offset:38912
    ds_read_b128 v[140:143], v4 offset:39424
    ds_read_b128 v[144:147], v4 offset:39936
    s_add_u32 s8, s46, 0
    s_addc_u32 s9, s47, 0
    s_mov_b32 s10, 1409024
    s_mov_b32 s11, 0x00020000
    s_add_u32 s12, s38, 0
    s_addc_u32 s13, s39, 0
    s_mov_b32 s14, 524288
    s_mov_b32 s15, 0x00020000
    s_lshr_b32 s78, s57, 1
    s_xor_b32 s78, s78, 4
    s_lshl_b32 s78, s78, 7
    s_lshl_b32 s79, s58, 10
    s_add_u32 m0, s79, 43008
    s_add_u32 s74, s78, 0
    buffer_load_dwordx4 v26, s[12:15], s74 offen lds
    s_add_u32 m0, s79, 51200
    s_add_u32 s74, s78, 65536
    buffer_load_dwordx4 v26, s[12:15], s74 offen lds
    s_add_u32 m0, s79, 59392
    s_add_u32 s74, s78, 131072
    buffer_load_dwordx4 v26, s[12:15], s74 offen lds
    s_add_u32 m0, s79, 67584
    s_add_u32 s74, s78, 196608
    buffer_load_dwordx4 v26, s[12:15], s74 offen lds
    s_waitcnt lgkmcnt(0)
    v_add_f32 v132, v132, v133
    v_add_f32 v134, v134, v135
    v_mul_f32 v132, 0x3b000000, v132
    v_mul_f32 v134, 0x3b000000, v134
    v_fma_f32 v134, -v132, v132, v134
    v_max_f32 v134, 0, v134
    v_mov_b32 v3, 0x3727c5ac
    v_fmac_f32 v3, 0x3f800000, v134
    v_rsq_f32 v31, v3
    v_cvt_pk_bf16_f32 v135, v132, v132
    v_and_b32 v135, 0xffff0000, v135
    v_sub_f32 v132, v132, v135
    v_mul_f32 v133, v3, v31
    v_cvt_pk_bf16_f32 v2, v133, v133
    v_and_b32 v2, 0xffff0000, v2
    v_sub_f32 v133, v133, v2
    v_cmp_gt_u32 vcc, 32, v1
    v_cvt_pk_bf16_f32 v148, v135, v132
    v_cvt_pk_bf16_f32 v149, v135, v2
    v_cvt_pk_bf16_f32 v150, v133, 0
    v_mov_b32 v151, 0
    v_cndmask_b32 v148, 0, v148, vcc
    v_cndmask_b32 v149, 0, v149, vcc
    v_cndmask_b32 v150, 0, v150, vcc
    v_add_f32 v136, v136, v137
    v_add_f32 v138, v138, v139
    v_add_f32 v136, v136, v138
    v_cvt_pk_bf16_f32 v152, -v136, -v136
    v_and_b32 v137, 0xffff0000, v152
    v_add_f32 v136, v136, v137
    v_cvt_pk_bf16_f32 v153, -v136, 0
    v_cvt_pk_bf16_f32 v154, 0, 0
    v_mov_b32 v155, 0
    v_add_f32 v140, v140, v141
    v_add_f32 v142, v142, v143
    v_add_f32 v140, v140, v142
    v_cvt_pk_bf16_f32 v156, -v140, -v140
    v_and_b32 v141, 0xffff0000, v156
    v_add_f32 v140, v140, v141
    v_cvt_pk_bf16_f32 v157, -v140, 0
    v_cvt_pk_bf16_f32 v158, 0, 0
    v_mov_b32 v159, 0
    v_add_f32 v144, v144, v145
    v_add_f32 v146, v146, v147
    v_add_f32 v144, v144, v146
    v_cvt_pk_bf16_f32 v160, -v144, -v144
    v_and_b32 v145, 0xffff0000, v160
    v_add_f32 v144, v144, v145
    v_cvt_pk_bf16_f32 v161, -v144, 0
    v_cvt_pk_bf16_f32 v162, 0, 0
    v_mov_b32 v163, 0
    s_add_u32 m0, s79, 75776
    s_add_u32 s74, s78, 262144
    buffer_load_dwordx4 v26, s[12:15], s74 offen lds
    s_add_u32 m0, s79, 83968
    s_add_u32 s74, s78, 327680
    buffer_load_dwordx4 v26, s[12:15], s74 offen lds
    v_mfma_f32_32x32x16_bf16 v[80:95], v[156:159], v[148:151], v[80:95]
    v_mfma_f32_32x32x16_bf16 v[64:79], v[152:155], v[148:151], v[64:79]
    v_mfma_f32_32x32x16_bf16 v[96:111], v[148:151], v[160:163], v[96:111]
    s_lshl_b32 s65, s58, 7
    v_lshl_add_u32 v3, v29, 2, s65
    v_lshl_add_u32 v4, v28, 4, s65
    v_bfe_u32 v2, v1, 2, 1
    v_cmp_eq_u32 vcc, 0, v2
    ds_write_b32 v3, v31 offset:34816
    ds_read_b128 v[32:35], v4 offset:34816
    ds_read_b128 v[36:39], v4 offset:34848
    ds_read_b128 v[40:43], v4 offset:34880
    ds_read_b128 v[44:47], v4 offset:34912
    v_lshl_or_b32 v112, v117, 16, v116
    v_lshl_or_b32 v113, v119, 16, v118
    v_lshl_or_b32 v114, v121, 16, v120
    v_lshl_or_b32 v115, v123, 16, v122
    v_cndmask_b32 v116, 0, v112, vcc
    v_cndmask_b32 v120, v112, 0, vcc
    v_cndmask_b32 v117, 0, v113, vcc
    v_cndmask_b32 v121, v113, 0, vcc
    v_cndmask_b32 v118, 0, v114, vcc
    v_cndmask_b32 v122, v114, 0, vcc
    v_cndmask_b32 v119, 0, v115, vcc
    v_cndmask_b32 v123, v115, 0, vcc
    s_mul_i32 s81, s56, 10240
    s_add_u32 s81, s81, 10494976
    s_mul_i32 s82, s57, 10240
    s_add_u32 s82, s82, 10494976
    v_cvt_pk_bf16_f32 v140, v80, v81
    v_cvt_pk_bf16_f32 v141, v82, v83
    v_cvt_pk_bf16_f32 v142, v84, v85
    v_cvt_pk_bf16_f32 v143, v86, v87
    v_cvt_pk_bf16_f32 v144, v88, v89
    v_cvt_pk_bf16_f32 v145, v90, v91
    v_cvt_pk_bf16_f32 v146, v92, v93
    v_cvt_pk_bf16_f32 v147, v94, v95
    v_mfma_f32_32x32x16_bf16 v[164:179], v[116:119], v[140:143], 0
    s_nop 0
    v_mfma_f32_32x32x16_bf16 v[164:179], v[120:123], v[144:147], v[164:179]
    v_cvt_pk_bf16_f32 v132, v64, v65
    v_cvt_pk_bf16_f32 v133, v66, v67
    v_cvt_pk_bf16_f32 v134, v68, v69
    v_cvt_pk_bf16_f32 v135, v70, v71
    v_cvt_pk_bf16_f32 v136, v72, v73
    v_cvt_pk_bf16_f32 v137, v74, v75
    v_cvt_pk_bf16_f32 v138, v76, v77
    v_cvt_pk_bf16_f32 v139, v78, v79
    v_mfma_f32_32x32x16_bf16 v[148:163], v[116:119], v[132:135], 0
    s_nop 0
    v_mfma_f32_32x32x16_bf16 v[148:163], v[120:123], v[136:139], v[148:163]
    s_add_u32 m0, s79, 92160
    s_add_u32 s74, s78, 393216
    buffer_load_dwordx4 v26, s[12:15], s74 offen lds
    s_add_u32 m0, s79, 100352
    s_add_u32 s74, s78, 458752
    buffer_load_dwordx4 v26, s[12:15], s74 offen lds
    v_mul_f32 v48, 0x3fb8aa3b, v31
    v_mul_f32 v50, 0xbfb8aa3b, v31
    s_waitcnt lgkmcnt(0)
    v_mul_f32 v96, v96, v32
    v_mul_f32 v97, v97, v33
    v_mul_f32 v98, v98, v34
    v_mul_f32 v99, v99, v35
    v_mul_f32 v100, v100, v36
    v_mul_f32 v101, v101, v37
    v_mul_f32 v102, v102, v38
    v_mul_f32 v103, v103, v39
    v_mul_f32 v104, v104, v40
    v_mul_f32 v105, v105, v41
    v_mul_f32 v106, v106, v42
    v_mul_f32 v107, v107, v43
    v_mul_f32 v108, v108, v44
    v_mul_f32 v109, v109, v45
    v_mul_f32 v110, v110, v46
    v_mul_f32 v111, v111, v47
    v_cvt_pk_bf16_f32 v64, v96, v97
    v_cvt_pk_bf16_f32 v65, v98, v99
    v_cvt_pk_bf16_f32 v66, v100, v101
    v_cvt_pk_bf16_f32 v67, v102, v103
    v_cvt_pk_bf16_f32 v68, v104, v105
    v_cvt_pk_bf16_f32 v69, v106, v107
    v_cvt_pk_bf16_f32 v70, v108, v109
    v_cvt_pk_bf16_f32 v71, v110, v111
    s_add_u32 m0, s79, 108544
    s_add_u32 s74, s78, 0
    buffer_load_dwordx4 v26, s[8:11], s74 offen lds
    s_add_u32 m0, s79, 116736
    s_add_u32 s74, s78, 65536
    buffer_load_dwordx4 v26, s[8:11], s74 offen lds
    v_max3_f32 v52, v164, v165, v166
    v_min3_f32 v54, v164, v165, v166
    v_max3_f32 v52, v52, v167, v168
    v_min3_f32 v54, v54, v167, v168
    v_max3_f32 v52, v52, v169, v170
    v_min3_f32 v54, v54, v169, v170
    v_max3_f32 v52, v52, v171, v172
    v_min3_f32 v54, v54, v171, v172
    v_max3_f32 v52, v52, v173, v174
    v_min3_f32 v54, v54, v173, v174
    v_max3_f32 v52, v52, v175, v176
    v_min3_f32 v54, v54, v175, v176
    v_max3_f32 v52, v52, v177, v178
    v_min3_f32 v54, v54, v177, v178
    v_max_f32 v52, v52, v179
    v_min_f32 v54, v54, v179
    v_mul_f32 v52, v52, v50
    v_mul_f32 v54, v54, v48
    s_add_u32 m0, s79, 124928
    s_add_u32 s74, s78, 131072
    buffer_load_dwordx4 v26, s[8:11], s74 offen lds
    s_add_u32 m0, s79, 133120
    s_add_u32 s74, s78, 196608
    buffer_load_dwordx4 v26, s[8:11], s74 offen lds
    v_pk_fma_f32 v[180:181], v[164:165], v[48:49], v[52:53] op_sel_hi:[1,0,0]
    v_pk_fma_f32 v[196:197], v[164:165], v[50:51], v[54:55] op_sel_hi:[1,0,0]
    v_pk_fma_f32 v[182:183], v[166:167], v[48:49], v[52:53] op_sel_hi:[1,0,0]
    v_pk_fma_f32 v[198:199], v[166:167], v[50:51], v[54:55] op_sel_hi:[1,0,0]
    v_pk_fma_f32 v[184:185], v[168:169], v[48:49], v[52:53] op_sel_hi:[1,0,0]
    v_pk_fma_f32 v[200:201], v[168:169], v[50:51], v[54:55] op_sel_hi:[1,0,0]
    v_pk_fma_f32 v[186:187], v[170:171], v[48:49], v[52:53] op_sel_hi:[1,0,0]
    v_pk_fma_f32 v[202:203], v[170:171], v[50:51], v[54:55] op_sel_hi:[1,0,0]
    v_pk_fma_f32 v[188:189], v[172:173], v[48:49], v[52:53] op_sel_hi:[1,0,0]
    v_pk_fma_f32 v[204:205], v[172:173], v[50:51], v[54:55] op_sel_hi:[1,0,0]
    v_pk_fma_f32 v[190:191], v[174:175], v[48:49], v[52:53] op_sel_hi:[1,0,0]
    v_pk_fma_f32 v[206:207], v[174:175], v[50:51], v[54:55] op_sel_hi:[1,0,0]
    v_pk_fma_f32 v[192:193], v[176:177], v[48:49], v[52:53] op_sel_hi:[1,0,0]
    v_pk_fma_f32 v[208:209], v[176:177], v[50:51], v[54:55] op_sel_hi:[1,0,0]
    v_pk_fma_f32 v[194:195], v[178:179], v[48:49], v[52:53] op_sel_hi:[1,0,0]
    v_pk_fma_f32 v[210:211], v[178:179], v[50:51], v[54:55] op_sel_hi:[1,0,0]
    v_exp_f32 v180, v180
    v_exp_f32 v196, v196
    v_exp_f32 v181, v181
    v_exp_f32 v197, v197
    v_exp_f32 v182, v182
    v_exp_f32 v198, v198
    v_exp_f32 v183, v183
    v_exp_f32 v199, v199
    v_exp_f32 v184, v184
    v_exp_f32 v200, v200
    v_exp_f32 v185, v185
    v_exp_f32 v201, v201
    v_exp_f32 v186, v186
    v_exp_f32 v202, v202
    v_exp_f32 v187, v187
    v_exp_f32 v203, v203
    s_add_u32 m0, s79, 141312
    s_add_u32 s74, s78, 262144
    buffer_load_dwordx4 v26, s[8:11], s74 offen lds
    s_add_u32 m0, s79, 149504
    s_add_u32 s74, s78, 327680
    buffer_load_dwordx4 v26, s[8:11], s74 offen lds
    v_exp_f32 v188, v188
    v_exp_f32 v204, v204
    v_exp_f32 v189, v189
    v_exp_f32 v205, v205
    v_exp_f32 v190, v190
    v_exp_f32 v206, v206
    v_exp_f32 v191, v191
    v_exp_f32 v207, v207
    v_exp_f32 v192, v192
    v_exp_f32 v208, v208
    v_exp_f32 v193, v193
    v_exp_f32 v209, v209
    v_exp_f32 v194, v194
    v_exp_f32 v210, v210
    v_exp_f32 v195, v195
    v_exp_f32 v211, v211
    v_pk_add_f32 v[56:57], v[180:181], v[182:183]
    v_pk_add_f32 v[58:59], v[196:197], v[198:199]
    v_pk_add_f32 v[56:57], v[56:57], v[184:185]
    v_pk_add_f32 v[58:59], v[58:59], v[200:201]
    v_pk_add_f32 v[56:57], v[56:57], v[186:187]
    v_pk_add_f32 v[58:59], v[58:59], v[202:203]
    v_pk_add_f32 v[56:57], v[56:57], v[188:189]
    v_pk_add_f32 v[58:59], v[58:59], v[204:205]
    v_pk_add_f32 v[56:57], v[56:57], v[190:191]
    v_pk_add_f32 v[58:59], v[58:59], v[206:207]
    v_pk_add_f32 v[56:57], v[56:57], v[192:193]
    v_pk_add_f32 v[58:59], v[58:59], v[208:209]
    v_pk_add_f32 v[56:57], v[56:57], v[194:195]
    v_pk_add_f32 v[58:59], v[58:59], v[210:211]
    v_add_f32 v56, v56, v57
    v_add_f32 v58, v58, v59
    v_rcp_f32 v56, v56
    v_rcp_f32 v58, v58
    v_pk_mul_f32 v[180:181], v[180:181], v[56:57] op_sel_hi:[1,0]
    v_pk_mul_f32 v[182:183], v[182:183], v[56:57] op_sel_hi:[1,0]
    v_pk_mul_f32 v[184:185], v[184:185], v[56:57] op_sel_hi:[1,0]
    v_pk_mul_f32 v[186:187], v[186:187], v[56:57] op_sel_hi:[1,0]
    v_pk_mul_f32 v[188:189], v[188:189], v[56:57] op_sel_hi:[1,0]
    v_pk_mul_f32 v[190:191], v[190:191], v[56:57] op_sel_hi:[1,0]
    v_pk_mul_f32 v[192:193], v[192:193], v[56:57] op_sel_hi:[1,0]
    v_pk_mul_f32 v[194:195], v[194:195], v[56:57] op_sel_hi:[1,0]
    v_cvt_pk_bf16_f32 v80, v180, v181
    v_cvt_pk_bf16_f32 v81, v182, v183
    v_cvt_pk_bf16_f32 v82, v184, v185
    v_cvt_pk_bf16_f32 v83, v186, v187
    v_cvt_pk_bf16_f32 v84, v188, v189
    v_cvt_pk_bf16_f32 v85, v190, v191
    v_cvt_pk_bf16_f32 v86, v192, v193
    v_cvt_pk_bf16_f32 v87, v194, v195
    v_pk_mul_f32 v[196:197], v[196:197], v[58:59] op_sel_hi:[1,0]
    v_pk_mul_f32 v[198:199], v[198:199], v[58:59] op_sel_hi:[1,0]
    v_pk_mul_f32 v[200:201], v[200:201], v[58:59] op_sel_hi:[1,0]
    v_pk_mul_f32 v[202:203], v[202:203], v[58:59] op_sel_hi:[1,0]
    v_pk_mul_f32 v[204:205], v[204:205], v[58:59] op_sel_hi:[1,0]
    v_pk_mul_f32 v[206:207], v[206:207], v[58:59] op_sel_hi:[1,0]
    v_pk_mul_f32 v[208:209], v[208:209], v[58:59] op_sel_hi:[1,0]
    v_pk_mul_f32 v[210:211], v[210:211], v[58:59] op_sel_hi:[1,0]
    v_cvt_pk_bf16_f32 v88, v196, v197
    v_cvt_pk_bf16_f32 v89, v198, v199
    v_cvt_pk_bf16_f32 v90, v200, v201
    v_cvt_pk_bf16_f32 v91, v202, v203
    v_cvt_pk_bf16_f32 v92, v204, v205
    v_cvt_pk_bf16_f32 v93, v206, v207
    v_cvt_pk_bf16_f32 v94, v208, v209
    v_cvt_pk_bf16_f32 v95, v210, v211
    v_mfma_f32_32x32x16_bf16 v[212:227], v[80:83], v[124:127], 0
    v_mfma_f32_32x32x16_bf16 v[212:227], v[84:87], v[128:131], v[212:227]
    v_mfma_f32_32x32x16_bf16 v[228:243], v[88:91], v[124:127], 0
    v_mfma_f32_32x32x16_bf16 v[228:243], v[92:95], v[128:131], v[228:243]
    v_max3_f32 v52, v148, v149, v150
    v_min3_f32 v54, v148, v149, v150
    v_max3_f32 v52, v52, v151, v152
    v_min3_f32 v54, v54, v151, v152
    v_max3_f32 v52, v52, v153, v154
    v_min3_f32 v54, v54, v153, v154
    v_max3_f32 v52, v52, v155, v156
    v_min3_f32 v54, v54, v155, v156
    v_max3_f32 v52, v52, v157, v158
    v_min3_f32 v54, v54, v157, v158
    v_max3_f32 v52, v52, v159, v160
    v_min3_f32 v54, v54, v159, v160
    v_max3_f32 v52, v52, v161, v162
    v_min3_f32 v54, v54, v161, v162
    v_max_f32 v52, v52, v163
    v_min_f32 v54, v54, v163
    v_mul_f32 v52, v52, v50
    v_mul_f32 v54, v54, v48
    v_cvt_pk_bf16_f32 v96, v212, v213
    v_cvt_pk_bf16_f32 v97, v214, v215
    v_cvt_pk_bf16_f32 v98, v216, v217
    v_cvt_pk_bf16_f32 v99, v218, v219
    v_cvt_pk_bf16_f32 v100, v220, v221
    v_cvt_pk_bf16_f32 v101, v222, v223
    v_cvt_pk_bf16_f32 v102, v224, v225
    v_cvt_pk_bf16_f32 v103, v226, v227
    v_mfma_f32_32x32x16_bf16 v[164:179], v[96:99], v[64:67], 0
    s_nop 0
    v_mfma_f32_32x32x16_bf16 v[164:179], v[100:103], v[68:71], v[164:179]
    v_cvt_pk_bf16_f32 v104, v228, v229
    v_cvt_pk_bf16_f32 v105, v230, v231
    v_cvt_pk_bf16_f32 v106, v232, v233
    v_cvt_pk_bf16_f32 v107, v234, v235
    v_cvt_pk_bf16_f32 v108, v236, v237
    v_cvt_pk_bf16_f32 v109, v238, v239
    v_cvt_pk_bf16_f32 v110, v240, v241
    v_cvt_pk_bf16_f32 v111, v242, v243
    v_mfma_f32_32x32x16_bf16 v[32:47], v[104:107], v[64:67], 0
    s_nop 0
    v_mfma_f32_32x32x16_bf16 v[32:47], v[108:111], v[68:71], v[32:47]
    v_add_f32 v212, v212, v220
    v_add_f32 v213, v213, v221
    v_add_f32 v214, v214, v222
    v_add_f32 v215, v215, v223
    v_add_f32 v216, v216, v224
    v_add_f32 v217, v217, v225
    v_add_f32 v218, v218, v226
    v_add_f32 v219, v219, v227
    v_add_f32 v228, v228, v236
    v_add_f32 v229, v229, v237
    v_add_f32 v230, v230, v238
    v_add_f32 v231, v231, v239
    v_add_f32 v232, v232, v240
    v_add_f32 v233, v233, v241
    v_add_f32 v234, v234, v242
    v_add_f32 v235, v235, v243
    v_add_f32 v212, v212, v216
    v_add_f32 v213, v213, v217
    v_add_f32 v214, v214, v218
    v_add_f32 v215, v215, v219
    v_add_f32 v228, v228, v232
    v_add_f32 v229, v229, v233
    v_add_f32 v230, v230, v234
    v_add_f32 v231, v231, v235
    v_add_f32 v212, v212, v214
    v_add_f32 v213, v213, v215
    v_add_f32 v228, v228, v230
    v_add_f32 v229, v229, v231
    v_add_f32 v212, v212, v213
    v_add_f32 v228, v228, v229
    s_lshl_b32 s65, s58, 12
    v_add_u32 v3, s65, v27
    s_lshl_b32 s65, s58, 8
    v_permlane32_swap_b32 v212, v228
    v_lshl_add_u32 v4, v1, 2, s65
    v_add_f32 v212, v212, v228
    s_mov_b32 exec_lo, 0xffff
    s_mov_b32 exec_hi, 0xffff
    ds_write_b128 v3, v[164:167] offset:0
    ds_write_b128 v3, v[168:171] offset:1024
    ds_write_b128 v3, v[32:35] offset:2048
    ds_write_b128 v3, v[36:39] offset:3072
    s_not_b64 exec, exec
    ds_write_b128 v3, v[172:175] offset:0
    ds_write_b128 v3, v[176:179] offset:1024
    ds_write_b128 v3, v[40:43] offset:2048
    ds_write_b128 v3, v[44:47] offset:3072
    s_mov_b64 exec, -1
    ds_write_b32 v4, v212 offset:32768
    s_lshl_b32 s64, s59, 7
    s_and_b32 s64, s64, 256
    s_and_b32 s63, s59, 1
    s_lshl_b32 s65, s63, 11
    s_add_u32 s65, s65, s64
    s_lshl_b32 s62, s60, 14
    s_add_u32 s65, s65, s62
    s_lshr_b32 s64, s64, 2
    s_lshl_b32 s63, s63, 7
    s_add_u32 s64, s64, s63
    s_lshl_b32 s62, s60, 10
    s_add_u32 s64, s64, s62
    s_add_u32 s64, s64, 32768
    v_and_b32 v2, 3, v1
    v_bfe_u32 v3, v1, 2, 1
    v_lshlrev_b32 v2, 2, v2
    v_lshl_or_b32 v4, v3, 10, v2
    v_lshl_or_b32 v2, v3, 5, v2
    v_lshrrev_b32 v3, 3, v1
    v_lshl_add_u32 v4, v3, 4, v4
    v_add_u32 v4, s65, v4
    v_add_u32 v5, 128, v4
    v_and_b32 v3, 1, v3
    v_lshl_add_u32 v3, v3, 4, v2
    v_add_u32 v3, s64, v3
    s_waitcnt vmcnt(14)
    s_cmp_lg_u32 s58, 0
    s_cbranch_scc1 QZCD
    s_mov_b32 s80, 400000
QZC:
    v_cmp_ne_u32 vcc, 0, v30
    s_and_b32 s65, vcc_lo, 0xffff
    s_cmp_eq_u32 s65, 0xffff
    s_cbranch_scc1 QZCD
    s_sub_u32 s80, s80, 1
    s_cbranch_scc1 QZCD
    v_lshlrev_b32 v30, 2, v1
    buffer_load_dword v30, v30, s[28:31], 0 offen sc1
    s_waitcnt vmcnt(0)
    s_branch QZC
QZCD:
    s_waitcnt lgkmcnt(0)
    s_barrier
    ds_read2st64_b32 v[212:213], v4 offset0:0 offset1:16
    ds_read2st64_b32 v[214:215], v4 offset0:32 offset1:48
    ds_read2st64_b32 v[216:217], v5 offset0:0 offset1:16
    ds_read2st64_b32 v[218:219], v5 offset0:32 offset1:48
    ds_read2st64_b32 v[220:221], v4 offset0:2 offset1:18
    ds_read2st64_b32 v[222:223], v4 offset0:34 offset1:50
    ds_read2st64_b32 v[224:225], v5 offset0:2 offset1:18
    ds_read2st64_b32 v[226:227], v5 offset0:34 offset1:50
    ds_read2st64_b32 v[228:229], v3 offset0:0 offset1:1
    ds_read2st64_b32 v[230:231], v3 offset0:2 offset1:3
    v_pk_fma_f32 v[180:181], v[148:149], v[48:49], v[52:53] op_sel_hi:[1,0,0]
    v_pk_fma_f32 v[196:197], v[148:149], v[50:51], v[54:55] op_sel_hi:[1,0,0]
    v_pk_fma_f32 v[182:183], v[150:151], v[48:49], v[52:53] op_sel_hi:[1,0,0]
    v_pk_fma_f32 v[198:199], v[150:151], v[50:51], v[54:55] op_sel_hi:[1,0,0]
    v_pk_fma_f32 v[184:185], v[152:153], v[48:49], v[52:53] op_sel_hi:[1,0,0]
    v_pk_fma_f32 v[200:201], v[152:153], v[50:51], v[54:55] op_sel_hi:[1,0,0]
    v_pk_fma_f32 v[186:187], v[154:155], v[48:49], v[52:53] op_sel_hi:[1,0,0]
    v_pk_fma_f32 v[202:203], v[154:155], v[50:51], v[54:55] op_sel_hi:[1,0,0]
    v_pk_fma_f32 v[188:189], v[156:157], v[48:49], v[52:53] op_sel_hi:[1,0,0]
    v_pk_fma_f32 v[204:205], v[156:157], v[50:51], v[54:55] op_sel_hi:[1,0,0]
    v_pk_fma_f32 v[190:191], v[158:159], v[48:49], v[52:53] op_sel_hi:[1,0,0]
    v_pk_fma_f32 v[206:207], v[158:159], v[50:51], v[54:55] op_sel_hi:[1,0,0]
    v_pk_fma_f32 v[192:193], v[160:161], v[48:49], v[52:53] op_sel_hi:[1,0,0]
    v_pk_fma_f32 v[208:209], v[160:161], v[50:51], v[54:55] op_sel_hi:[1,0,0]
    v_pk_fma_f32 v[194:195], v[162:163], v[48:49], v[52:53] op_sel_hi:[1,0,0]
    v_pk_fma_f32 v[210:211], v[162:163], v[50:51], v[54:55] op_sel_hi:[1,0,0]
    s_mul_i32 s65, s58, 1152
    s_add_u32 s64, s82, s65
    s_sub_u32 s64, s64, 9216
    v_lshlrev_b32 v2, 2, v1
    s_waitcnt lgkmcnt(0)
    v_add_f32 v212, v212, v213
    v_add_f32 v214, v214, v215
    v_add_f32 v216, v216, v217
    v_add_f32 v218, v218, v219
    v_add_f32 v220, v220, v221
    v_add_f32 v222, v222, v223
    v_add_f32 v224, v224, v225
    v_add_f32 v226, v226, v227
    v_add_f32 v228, v228, v229
    v_add_f32 v230, v230, v231
    v_add_f32 v212, v212, v214
    v_add_f32 v216, v216, v218
    v_add_f32 v220, v220, v222
    v_add_f32 v224, v224, v226
    v_add_f32 v228, v228, v230
    buffer_atomic_add_f32 v212, v2, s[20:23], s64 offen offset:0
    buffer_atomic_add_f32 v216, v2, s[20:23], s64 offen offset:256
    buffer_atomic_add_f32 v220, v2, s[20:23], s64 offen offset:512
    buffer_atomic_add_f32 v224, v2, s[20:23], s64 offen offset:768
    s_mov_b64 exec, 0xffff
    buffer_atomic_add_f32 v228, v2, s[20:23], s64 offen offset:1024
    s_mov_b64 exec, -1
    v_exp_f32 v180, v180
    v_exp_f32 v196, v196
    v_exp_f32 v181, v181
    v_exp_f32 v197, v197
    v_exp_f32 v182, v182
    v_exp_f32 v198, v198
    v_exp_f32 v183, v183
    v_exp_f32 v199, v199
    v_exp_f32 v184, v184
    v_exp_f32 v200, v200
    v_exp_f32 v185, v185
    v_exp_f32 v201, v201
    v_exp_f32 v186, v186
    v_exp_f32 v202, v202
    v_exp_f32 v187, v187
    v_exp_f32 v203, v203
    v_exp_f32 v188, v188
    v_exp_f32 v204, v204
    v_exp_f32 v189, v189
    v_exp_f32 v205, v205
    v_exp_f32 v190, v190
    v_exp_f32 v206, v206
    v_exp_f32 v191, v191
    v_exp_f32 v207, v207
    v_exp_f32 v192, v192
    v_exp_f32 v208, v208
    v_exp_f32 v193, v193
    v_exp_f32 v209, v209
    v_exp_f32 v194, v194
    v_exp_f32 v210, v210
    v_exp_f32 v195, v195
    v_exp_f32 v211, v211
    s_cmp_lg_u32 s58, 0
    s_cbranch_scc1 QHI
    buffer_load_dword v30, off, s[20:23], s81 offset:256 sc1
QHI:
    v_pk_add_f32 v[56:57], v[180:181], v[182:183]
    v_pk_add_f32 v[58:59], v[196:197], v[198:199]
    v_pk_add_f32 v[56:57], v[56:57], v[184:185]
    v_pk_add_f32 v[58:59], v[58:59], v[200:201]
    v_pk_add_f32 v[56:57], v[56:57], v[186:187]
    v_pk_add_f32 v[58:59], v[58:59], v[202:203]
    v_pk_add_f32 v[56:57], v[56:57], v[188:189]
    v_pk_add_f32 v[58:59], v[58:59], v[204:205]
    v_pk_add_f32 v[56:57], v[56:57], v[190:191]
    v_pk_add_f32 v[58:59], v[58:59], v[206:207]
    v_pk_add_f32 v[56:57], v[56:57], v[192:193]
    v_pk_add_f32 v[58:59], v[58:59], v[208:209]
    v_pk_add_f32 v[56:57], v[56:57], v[194:195]
    v_pk_add_f32 v[58:59], v[58:59], v[210:211]
    v_add_f32 v56, v56, v57
    v_add_f32 v58, v58, v59
    v_rcp_f32 v56, v56
    v_rcp_f32 v58, v58
    v_pk_mul_f32 v[180:181], v[180:181], v[56:57] op_sel_hi:[1,0]
    v_pk_mul_f32 v[182:183], v[182:183], v[56:57] op_sel_hi:[1,0]
    v_pk_mul_f32 v[184:185], v[184:185], v[56:57] op_sel_hi:[1,0]
    v_pk_mul_f32 v[186:187], v[186:187], v[56:57] op_sel_hi:[1,0]
    v_pk_mul_f32 v[188:189], v[188:189], v[56:57] op_sel_hi:[1,0]
    v_pk_mul_f32 v[190:191], v[190:191], v[56:57] op_sel_hi:[1,0]
    v_pk_mul_f32 v[192:193], v[192:193], v[56:57] op_sel_hi:[1,0]
    v_pk_mul_f32 v[194:195], v[194:195], v[56:57] op_sel_hi:[1,0]
    v_cvt_pk_bf16_f32 v80, v180, v181
    v_cvt_pk_bf16_f32 v81, v182, v183
    v_cvt_pk_bf16_f32 v82, v184, v185
    v_cvt_pk_bf16_f32 v83, v186, v187
    v_cvt_pk_bf16_f32 v84, v188, v189
    v_cvt_pk_bf16_f32 v85, v190, v191
    v_cvt_pk_bf16_f32 v86, v192, v193
    v_cvt_pk_bf16_f32 v87, v194, v195
    v_pk_mul_f32 v[196:197], v[196:197], v[58:59] op_sel_hi:[1,0]
    v_pk_mul_f32 v[198:199], v[198:199], v[58:59] op_sel_hi:[1,0]
    v_pk_mul_f32 v[200:201], v[200:201], v[58:59] op_sel_hi:[1,0]
    v_pk_mul_f32 v[202:203], v[202:203], v[58:59] op_sel_hi:[1,0]
    v_pk_mul_f32 v[204:205], v[204:205], v[58:59] op_sel_hi:[1,0]
    v_pk_mul_f32 v[206:207], v[206:207], v[58:59] op_sel_hi:[1,0]
    v_pk_mul_f32 v[208:209], v[208:209], v[58:59] op_sel_hi:[1,0]
    v_pk_mul_f32 v[210:211], v[210:211], v[58:59] op_sel_hi:[1,0]
    v_cvt_pk_bf16_f32 v88, v196, v197
    v_cvt_pk_bf16_f32 v89, v198, v199
    v_cvt_pk_bf16_f32 v90, v200, v201
    v_cvt_pk_bf16_f32 v91, v202, v203
    v_cvt_pk_bf16_f32 v92, v204, v205
    v_cvt_pk_bf16_f32 v93, v206, v207
    v_cvt_pk_bf16_f32 v94, v208, v209
    v_cvt_pk_bf16_f32 v95, v210, v211
    s_waitcnt vmcnt(0)
    s_barrier
    s_cmp_lg_u32 s58, 0
    s_cbranch_scc1 QSK
    s_mov_b64 exec, 1
    v_mov_b32 v5, 1
    buffer_atomic_add v5, off, s[20:23], s82 offset:0
    s_mov_b64 exec, -1
QSK:
    s_add_u32 m0, s79, 0
    s_add_u32 s74, s78, 393216
    buffer_load_dwordx4 v26, s[8:11], s74 offen lds
    s_add_u32 m0, s79, 8192
    s_add_u32 s74, s78, 458752
    buffer_load_dwordx4 v26, s[8:11], s74 offen lds
    s_add_u32 m0, s79, 16384
    s_add_u32 s74, s78, 524288
    buffer_load_dwordx4 v26, s[8:11], s74 offen lds
    s_add_u32 m0, s79, 24576
    s_add_u32 s74, s78, 589824
    buffer_load_dwordx4 v26, s[8:11], s74 offen lds
    s_add_u32 m0, s79, 32768
    s_add_u32 s74, s78, 655360
    buffer_load_dwordx4 v26, s[8:11], s74 offen lds
    s_lshr_b32 s66, s58, 1
    s_and_b32 s67, s58, 1
    s_and_b32 s64, s57, 1
    s_lshl_b32 s71, s64, 16
    s_lshl_b32 s64, s64, 1
    s_add_u32 s64, s64, s67
    s_lshl_b32 s65, s56, 2
    s_add_u32 s64, s64, s65
    s_mul_i32 s62, s64, 86
    s_add_u32 s62, s62, s66
    s_lshl_b32 s62, s62, 10
    s_lshl_b32 s63, s64, 5
    s_add_u32 s63, s63, s66
    s_lshl_b32 s63, s63, 10
    s_add_u32 s63, s63, 6291456
    s_lshl_b32 s72, s58, 13
    s_add_u32 s71, s71, s72
    s_add_u32 s71, s71, s78
    s_lshl_b32 s65, s56, 17
    v_lshrrev_b32 v4, 3, v1
    v_and_b32 v3, 7, v1
    v_lshlrev_b32 v3, 4, v3
    v_lshl_add_u32 v7, v4, 10, v3
    s_add_u32 s16, s50, s65
    s_addc_u32 s17, s51, 0
    s_mov_b32 s18, 131072
    s_mov_b32 s19, 0x00020000
    s_add_u32 s24, s48, 0
    s_addc_u32 s25, s49, 0
    s_mov_b32 s26, 1024
    s_mov_b32 s27, 0x00020000
    s_sub_u32 s64, s66, s69
    s_lshl_b32 s64, s64, 11
    s_sub_u32 s64, s64, 0x10000
    s_lshl_b32 s65, s60, 6
    v_add_u32 v2, s64, v14
    v_xor_b32 v10, s65, v2
    v_xor_b32 v11, 64, v10
    v_add_u32 v12, 0xf000, v10
    v_add_u32 v13, 0xf000, v11
    v_add_u32 v14, 0x1e000, v10
    v_add_u32 v15, 0x1e000, v11
    ds_read_b64_tr_b16 v[160:161], v10 offset:43008
    ds_read_b64_tr_b16 v[162:163], v10 offset:43520
    ds_read_b64_tr_b16 v[164:165], v11 offset:43008
    ds_read_b64_tr_b16 v[166:167], v11 offset:43520
    ds_read_b64_tr_b16 v[168:169], v10 offset:51200
    ds_read_b64_tr_b16 v[170:171], v10 offset:51712
    ds_read_b64_tr_b16 v[172:173], v11 offset:51200
    ds_read_b64_tr_b16 v[174:175], v11 offset:51712
    ds_read_b64_tr_b16 v[176:177], v10 offset:59392
    ds_read_b64_tr_b16 v[178:179], v10 offset:59904
    ds_read_b64_tr_b16 v[180:181], v11 offset:59392
    ds_read_b64_tr_b16 v[182:183], v11 offset:59904
    ds_read_b64_tr_b16 v[184:185], v12 offset:6144
    ds_read_b64_tr_b16 v[186:187], v12 offset:6656
    ds_read_b64_tr_b16 v[188:189], v13 offset:6144
    ds_read_b64_tr_b16 v[190:191], v13 offset:6656
    ds_read_b64_tr_b16 v[192:193], v12 offset:14336
    ds_read_b64_tr_b16 v[194:195], v12 offset:14848
    ds_read_b64_tr_b16 v[196:197], v13 offset:14336
    ds_read_b64_tr_b16 v[198:199], v13 offset:14848
    ds_read_b64_tr_b16 v[200:201], v12 offset:22528
    ds_read_b64_tr_b16 v[202:203], v12 offset:23040
    ds_read_b64_tr_b16 v[204:205], v13 offset:22528
    ds_read_b64_tr_b16 v[206:207], v13 offset:23040
    ds_read_b64_tr_b16 v[208:209], v12 offset:30720
    ds_read_b64_tr_b16 v[210:211], v12 offset:31232
    ds_read_b64_tr_b16 v[212:213], v13 offset:30720
    ds_read_b64_tr_b16 v[214:215], v13 offset:31232
    ds_read_b64_tr_b16 v[216:217], v12 offset:38912
    ds_read_b64_tr_b16 v[218:219], v12 offset:39424
    ds_read_b64_tr_b16 v[220:221], v13 offset:38912
    ds_read_b64_tr_b16 v[222:223], v13 offset:39424
    s_waitcnt lgkmcnt(0)
    s_barrier
    s_add_u32 m0, s79, 43008
    s_add_u32 s74, s78, 720896
    buffer_load_dwordx4 v26, s[8:11], s74 offen lds
    s_add_u32 m0, s79, 51200
    s_add_u32 s74, s78, 786432
    buffer_load_dwordx4 v26, s[8:11], s74 offen lds
    s_add_u32 m0, s79, 59392
    s_add_u32 s74, s78, 851968
    buffer_load_dwordx4 v26, s[8:11], s74 offen lds
    s_add_u32 m0, s79, 67584
    s_add_u32 s74, s78, 917504
    buffer_load_dwordx4 v26, s[8:11], s74 offen lds
    s_add_u32 m0, s79, 75776
    s_add_u32 s74, s78, 983040
    buffer_load_dwordx4 v26, s[8:11], s74 offen lds
    s_add_u32 m0, s79, 83968
    s_add_u32 s74, s78, 1048576
    buffer_load_dwordx4 v26, s[8:11], s74 offen lds
    s_add_u32 m0, s79, 92160
    s_add_u32 s74, s78, 1114112
    buffer_load_dwordx4 v26, s[8:11], s74 offen lds
    s_add_u32 m0, s79, 100352
    s_add_u32 s74, s78, 1179648
    buffer_load_dwordx4 v26, s[8:11], s74 offen lds
    ds_read_b64_tr_b16 v[64:65], v12 offset:47104
    ds_read_b64_tr_b16 v[66:67], v12 offset:47616
    ds_read_b64_tr_b16 v[68:69], v13 offset:47104
    ds_read_b64_tr_b16 v[70:71], v13 offset:47616
    v_lshrrev_b32 v2, 4, v29
    v_cmp_eq_u32 s[72:73], v2, v28
    v_and_b32 v2, 15, v29
    v_lshlrev_b32 v2, 4, v2
    v_add_u32 v3, 256, v2
    v_mov_b32 v4, 512
    v_cndmask_b32 v2, v4, v2, s[72:73]
    v_mov_b32 v4, 528
    v_cndmask_b32 v3, v4, v3, s[72:73]
    s_mul_i32 s61, s60, 2176
    s_add_u32 s61, s61, 157696
    v_mul_u32_u24 v4, 1088, v28
    v_add_u32 v4, s61, v4
    v_add_u32 v8, v2, v4
    v_add_u32 v9, v3, v4
    s_mul_i32 s61, s58, 544
    s_add_u32 s61, s61, 157696
    v_lshl_add_u32 v6, v1, 3, s61
    s_mul_i32 s61, s58, 1152
    s_add_u32 s61, s61, s82
    s_sub_u32 s61, s61, 9216
    s_lshl_b32 s68, s56, 2
    s_add_u32 s68, s68, s59
    s_lshl_b32 s68, s68, 5
    s_add_u32 s68, s68, s77
    s_lshl_b32 s68, s68, 10
    s_add_u32 s68, s68, 6291456
    s_mov_b32 s70, 0x358637bd
    s_cmp_lg_u32 s58, 0
    s_cbranch_scc1 PQHD
    s_mov_b32 s80, 400000
PQH:
    v_readfirstlane_b32 s65, v30
    s_nop 0
    s_cmp_ge_u32 s65, 8
    s_cbranch_scc1 PQHD
    s_sub_u32 s80, s80, 1
    s_cbranch_scc1 PQHD
    buffer_load_dword v30, off, s[20:23], s81 offset:256 sc1
    s_waitcnt vmcnt(0)
    s_branch PQH
PQHD:
    s_cmp_lg_u32 s58, 0
    s_cbranch_scc1 PQKD
    s_mov_b32 s80, 400000
PQK:
    v_readfirstlane_b32 s65, v30
    s_nop 0
    s_cmp_ge_u32 s65, 16
    s_cbranch_scc1 PQKD
    s_sub_u32 s80, s80, 1
    s_cbranch_scc1 PQKD
    buffer_load_dword v30, off, s[20:23], s82 offset:0 sc1
    s_waitcnt vmcnt(0)
    s_branch PQK
PQKD:
    s_barrier
    buffer_load_dwordx4 v[224:227], v27, s[20:23], s61 offen sc1
    s_mov_b64 exec, 15
    buffer_load_dwordx4 v[228:231], v27, s[20:23], s61 offen offset:1024 sc1
    s_mov_b64 exec, -1
    buffer_load_dwordx4 v[112:115], v27, s[20:23], s62 offen sc1
    s_add_u32 s62, s62, 4096
    buffer_load_dwordx4 v[116:119], v27, s[20:23], s62 offen sc1
    s_add_u32 s62, s62, 4096
    buffer_load_dwordx4 v[120:123], v27, s[20:23], s62 offen sc1
    s_add_u32 s62, s62, 4096
    buffer_load_dwordx4 v[124:127], v27, s[20:23], s62 offen sc1
    s_add_u32 s62, s62, 4096
    buffer_load_dwordx4 v[128:131], v27, s[20:23], s62 offen sc1
    s_add_u32 s62, s62, 4096
    buffer_load_dwordx4 v[132:135], v27, s[20:23], s62 offen sc1
    s_add_u32 s62, s62, 4096
    buffer_load_dwordx4 v[136:139], v27, s[20:23], s62 offen sc1
    s_add_u32 s62, s62, 4096
    buffer_load_dwordx4 v[140:143], v27, s[20:23], s62 offen sc1
    s_add_u32 s62, s62, 4096
    s_waitcnt vmcnt(8)
    v_cvt_pk_bf16_f32 v16, v224, v225
    v_cvt_pk_bf16_f32 v17, v226, v227
    v_cvt_pk_bf16_f32 v18, v228, v229
    v_cvt_pk_bf16_f32 v19, v230, v231
    ds_write_b64 v6, v[16:17]
    s_mov_b64 exec, 15
    ds_write_b64 v6, v[18:19] offset:512
    s_mov_b64 exec, -1
    s_waitcnt lgkmcnt(0)
    s_barrier
    ds_read_b128 v[224:227], v8 offset:0
    ds_read_b128 v[232:235], v9 offset:0
    ds_read_b128 v[240:243], v8 offset:544
    ds_read_b128 v[248:251], v9 offset:544
    s_waitcnt lgkmcnt(3)
    v_cndmask_b32 v228, v224, 0, s[72:73]
    v_cndmask_b32 v229, v225, 0, s[72:73]
    v_cndmask_b32 v230, v226, 0, s[72:73]
    v_cndmask_b32 v231, v227, 0, s[72:73]
    s_nop 1
    v_mfma_f32_32x32x16_bf16 v[96:111], v[228:231], v[80:83], 0
    v_cndmask_b32 v224, 0, v224, s[72:73]
    v_cndmask_b32 v225, 0, v225, s[72:73]
    v_cndmask_b32 v226, 0, v226, s[72:73]
    v_cndmask_b32 v227, 0, v227, s[72:73]
    s_nop 1
    v_mfma_f32_32x32x16_bf16 v[144:159], v[224:227], v[80:83], 0
    s_waitcnt lgkmcnt(2)
    v_cndmask_b32 v236, v232, 0, s[72:73]
    v_cndmask_b32 v237, v233, 0, s[72:73]
    v_cndmask_b32 v238, v234, 0, s[72:73]
    v_cndmask_b32 v239, v235, 0, s[72:73]
    s_nop 1
    v_mfma_f32_32x32x16_bf16 v[96:111], v[236:239], v[84:87], v[96:111]
    v_cndmask_b32 v232, 0, v232, s[72:73]
    v_cndmask_b32 v233, 0, v233, s[72:73]
    v_cndmask_b32 v234, 0, v234, s[72:73]
    v_cndmask_b32 v235, 0, v235, s[72:73]
    s_nop 1
    v_mfma_f32_32x32x16_bf16 v[144:159], v[232:235], v[84:87], v[144:159]
    s_waitcnt lgkmcnt(1)
    v_cndmask_b32 v244, v240, 0, s[72:73]
    v_cndmask_b32 v245, v241, 0, s[72:73]
    v_cndmask_b32 v246, v242, 0, s[72:73]
    v_cndmask_b32 v247, v243, 0, s[72:73]
    s_nop 1
    v_mfma_f32_32x32x16_bf16 v[96:111], v[244:247], v[88:91], v[96:111]
    v_cndmask_b32 v240, 0, v240, s[72:73]
    v_cndmask_b32 v241, 0, v241, s[72:73]
    v_cndmask_b32 v242, 0, v242, s[72:73]
    v_cndmask_b32 v243, 0, v243, s[72:73]
    s_nop 1
    v_mfma_f32_32x32x16_bf16 v[144:159], v[240:243], v[88:91], v[144:159]
    s_waitcnt lgkmcnt(0)
    v_cndmask_b32 v252, v248, 0, s[72:73]
    v_cndmask_b32 v253, v249, 0, s[72:73]
    v_cndmask_b32 v254, v250, 0, s[72:73]
    v_cndmask_b32 v255, v251, 0, s[72:73]
    s_nop 1
    v_mfma_f32_32x32x16_bf16 v[96:111], v[252:255], v[92:95], v[96:111]
    v_cndmask_b32 v248, 0, v248, s[72:73]
    v_cndmask_b32 v249, 0, v249, s[72:73]
    v_cndmask_b32 v250, 0, v250, s[72:73]
    v_cndmask_b32 v251, 0, v251, s[72:73]
    s_nop 1
    v_mfma_f32_32x32x16_bf16 v[144:159], v[248:251], v[92:95], v[144:159]
    s_nop 4
    v_add_f32 v96, s70, v96
    v_add_f32 v104, s70, v104
    v_rcp_f32 v96, v96
    v_rcp_f32 v104, v104
    s_nop 2
    v_mul_f32 v144, v144, v104
    v_mul_f32 v145, v145, v104
    v_mul_f32 v146, v146, v104
    v_mul_f32 v147, v147, v104
    v_mul_f32 v148, v148, v104
    v_mul_f32 v149, v149, v104
    v_mul_f32 v150, v150, v104
    v_mul_f32 v151, v151, v104
    v_mul_f32 v152, v152, v96
    v_mul_f32 v153, v153, v96
    v_mul_f32 v154, v154, v96
    v_mul_f32 v155, v155, v96
    v_mul_f32 v156, v156, v96
    v_mul_f32 v157, v157, v96
    v_mul_f32 v158, v158, v96
    v_mul_f32 v159, v159, v96
    v_cvt_pk_bf16_f32 v144, v144, v145
    v_cvt_pk_bf16_f32 v145, v146, v147
    v_cvt_pk_bf16_f32 v146, v148, v149
    v_cvt_pk_bf16_f32 v147, v150, v151
    v_cvt_pk_bf16_f32 v148, v152, v153
    v_cvt_pk_bf16_f32 v149, v154, v155
    v_cvt_pk_bf16_f32 v150, v156, v157
    v_cvt_pk_bf16_f32 v151, v158, v159
    buffer_store_dwordx4 v[144:147], v27, s[20:23], s68 offen offset:0 sc1
    buffer_store_dwordx4 v[148:151], v27, s[20:23], s68 offen offset:1024 sc1
    ds_read_b64_tr_b16 v[72:73], v12 offset:55296
    ds_read_b64_tr_b16 v[74:75], v12 offset:55808
    ds_read_b64_tr_b16 v[76:77], v13 offset:55296
    ds_read_b64_tr_b16 v[78:79], v13 offset:55808
    s_waitcnt vmcnt(9)
    v_mfma_f32_32x32x16_bf16 v[32:47], v[64:67], v[112:115], 0
    v_mfma_f32_32x32x16_bf16 v[48:63], v[68:71], v[112:115], 0
    buffer_load_dwordx4 v[112:115], v27, s[20:23], s62 offen sc1
    s_add_u32 s62, s62, 4096
    v_and_b32 v3, 0x70, v7
    buffer_load_dwordx4 v[104:107], v7, s[4:7], s71 offen
    buffer_load_dwordx4 v[108:111], v3, s[24:27], s78 offen
    ds_read_b64_tr_b16 v[64:65], v14 offset:2048
    ds_read_b64_tr_b16 v[66:67], v14 offset:2560
    ds_read_b64_tr_b16 v[68:69], v15 offset:2048
    ds_read_b64_tr_b16 v[70:71], v15 offset:2560
    s_waitcnt lgkmcnt(4)
    s_waitcnt vmcnt(11)
    v_mfma_f32_32x32x16_bf16 v[32:47], v[72:75], v[116:119], v[32:47]
    v_mfma_f32_32x32x16_bf16 v[48:63], v[76:79], v[116:119], v[48:63]
    buffer_load_dwordx4 v[116:119], v27, s[20:23], s62 offen sc1
    s_add_u32 s62, s62, 4096
    ds_read_b64_tr_b16 v[72:73], v14 offset:10240
    ds_read_b64_tr_b16 v[74:75], v14 offset:10752
    ds_read_b64_tr_b16 v[76:77], v15 offset:10240
    ds_read_b64_tr_b16 v[78:79], v15 offset:10752
    s_waitcnt lgkmcnt(4)
    s_waitcnt vmcnt(11)
    v_mfma_f32_32x32x16_bf16 v[32:47], v[64:67], v[120:123], v[32:47]
    v_mfma_f32_32x32x16_bf16 v[48:63], v[68:71], v[120:123], v[48:63]
    buffer_load_dwordx4 v[120:123], v27, s[20:23], s62 offen sc1
    s_add_u32 s62, s62, 4096
    ds_read_b64_tr_b16 v[64:65], v14 offset:18432
    ds_read_b64_tr_b16 v[66:67], v14 offset:18944
    ds_read_b64_tr_b16 v[68:69], v15 offset:18432
    ds_read_b64_tr_b16 v[70:71], v15 offset:18944
    s_waitcnt lgkmcnt(4)
    s_waitcnt vmcnt(11)
    v_mfma_f32_32x32x16_bf16 v[32:47], v[72:75], v[124:127], v[32:47]
    v_mfma_f32_32x32x16_bf16 v[48:63], v[76:79], v[124:127], v[48:63]
    s_barrier
    buffer_load_dwordx4 v[124:127], v27, s[20:23], s62 offen sc1
    s_add_u32 s62, s62, 4096
    s_add_u32 m0, s79, 108544
    s_add_u32 s74, s78, 1245184
    buffer_load_dwordx4 v26, s[8:11], s74 offen lds
    ds_read_b64_tr_b16 v[72:73], v14 offset:26624
    ds_read_b64_tr_b16 v[74:75], v14 offset:27136
    ds_read_b64_tr_b16 v[76:77], v15 offset:26624
    ds_read_b64_tr_b16 v[78:79], v15 offset:27136
    s_waitcnt lgkmcnt(4)
    s_waitcnt vmcnt(12)
    v_mfma_f32_32x32x16_bf16 v[32:47], v[64:67], v[128:131], v[32:47]
    v_mfma_f32_32x32x16_bf16 v[48:63], v[68:71], v[128:131], v[48:63]
    buffer_load_dwordx4 v[128:131], v27, s[20:23], s62 offen sc1
    s_add_u32 s62, s62, 4096
    s_add_u32 m0, s79, 116736
    s_add_u32 s74, s78, 1310720
    buffer_load_dwordx4 v26, s[8:11], s74 offen lds
    ds_read_b64_tr_b16 v[64:65], v10 offset:0
    ds_read_b64_tr_b16 v[66:67], v10 offset:512
    ds_read_b64_tr_b16 v[68:69], v11 offset:0
    ds_read_b64_tr_b16 v[70:71], v11 offset:512
    s_waitcnt lgkmcnt(4)
    s_waitcnt vmcnt(13)
    v_mfma_f32_32x32x16_bf16 v[32:47], v[72:75], v[132:135], v[32:47]
    v_mfma_f32_32x32x16_bf16 v[48:63], v[76:79], v[132:135], v[48:63]
    buffer_load_dwordx4 v[132:135], v27, s[20:23], s62 offen sc1
    s_add_u32 s62, s62, 4096
    s_add_u32 m0, s79, 124928
    s_add_u32 s74, s78, 1376256
    buffer_load_dwordx4 v26, s[8:11], s74 offen lds
    s_waitcnt vmcnt(11)
    s_barrier
    s_cmp_lg_u32 s58, 0
    s_cbranch_scc1 PQSO
    s_mov_b64 exec, 1
    v_mov_b32 v5, 1
    buffer_atomic_add v5, off, s[20:23], s81 offset:512
    s_mov_b64 exec, -1
PQSO:
    ds_read_b64_tr_b16 v[72:73], v10 offset:8192
    ds_read_b64_tr_b16 v[74:75], v10 offset:8704
    ds_read_b64_tr_b16 v[76:77], v11 offset:8192
    ds_read_b64_tr_b16 v[78:79], v11 offset:8704
    s_waitcnt lgkmcnt(4)
    v_mfma_f32_32x32x16_bf16 v[32:47], v[64:67], v[136:139], v[32:47]
    v_mfma_f32_32x32x16_bf16 v[48:63], v[68:71], v[136:139], v[48:63]
    buffer_load_dwordx4 v[136:139], v27, s[20:23], s62 offen sc1
    s_add_u32 s62, s62, 4096
    ds_read_b64_tr_b16 v[64:65], v10 offset:16384
    ds_read_b64_tr_b16 v[66:67], v10 offset:16896
    ds_read_b64_tr_b16 v[68:69], v11 offset:16384
    ds_read_b64_tr_b16 v[70:71], v11 offset:16896
    s_waitcnt lgkmcnt(4)
    v_mfma_f32_32x32x16_bf16 v[32:47], v[72:75], v[140:143], v[32:47]
    v_mfma_f32_32x32x16_bf16 v[48:63], v[76:79], v[140:143], v[48:63]
    buffer_load_dwordx4 v[140:143], v27, s[20:23], s62 offen sc1
    s_add_u32 s62, s62, 4096
    ds_read_b64_tr_b16 v[72:73], v10 offset:24576
    ds_read_b64_tr_b16 v[74:75], v10 offset:25088
    ds_read_b64_tr_b16 v[76:77], v11 offset:24576
    ds_read_b64_tr_b16 v[78:79], v11 offset:25088
    s_waitcnt lgkmcnt(4)
    s_waitcnt vmcnt(12)
    v_mfma_f32_32x32x16_bf16 v[32:47], v[64:67], v[112:115], v[32:47]
    v_mfma_f32_32x32x16_bf16 v[48:63], v[68:71], v[112:115], v[48:63]
    buffer_load_dwordx4 v[112:115], v27, s[20:23], s62 offen sc1
    s_add_u32 s62, s62, 4096
    ds_read_b64_tr_b16 v[64:65], v10 offset:32768
    ds_read_b64_tr_b16 v[66:67], v10 offset:33280
    ds_read_b64_tr_b16 v[68:69], v11 offset:32768
    ds_read_b64_tr_b16 v[70:71], v11 offset:33280
    s_waitcnt lgkmcnt(4)
    s_waitcnt vmcnt(10)
    v_mfma_f32_32x32x16_bf16 v[32:47], v[72:75], v[116:119], v[32:47]
    v_mfma_f32_32x32x16_bf16 v[48:63], v[76:79], v[116:119], v[48:63]
    buffer_load_dwordx4 v[116:119], v27, s[20:23], s62 offen sc1
    s_add_u32 s62, s62, 4096
    ds_read_b64_tr_b16 v[72:73], v10 offset:43008
    ds_read_b64_tr_b16 v[74:75], v10 offset:43520
    ds_read_b64_tr_b16 v[76:77], v11 offset:43008
    ds_read_b64_tr_b16 v[78:79], v11 offset:43520
    s_waitcnt lgkmcnt(4)
    s_waitcnt vmcnt(10)
    v_mfma_f32_32x32x16_bf16 v[32:47], v[64:67], v[120:123], v[32:47]
    v_mfma_f32_32x32x16_bf16 v[48:63], v[68:71], v[120:123], v[48:63]
    buffer_load_dwordx4 v[120:123], v27, s[20:23], s62 offen sc1
    s_add_u32 s62, s62, 4096
    ds_read_b64_tr_b16 v[64:65], v10 offset:51200
    ds_read_b64_tr_b16 v[66:67], v10 offset:51712
    ds_read_b64_tr_b16 v[68:69], v11 offset:51200
    ds_read_b64_tr_b16 v[70:71], v11 offset:51712
    s_waitcnt lgkmcnt(4)
    s_waitcnt vmcnt(10)
    v_mfma_f32_32x32x16_bf16 v[32:47], v[72:75], v[124:127], v[32:47]
    v_mfma_f32_32x32x16_bf16 v[48:63], v[76:79], v[124:127], v[48:63]
    buffer_load_dwordx4 v[124:127], v27, s[20:23], s62 offen sc1
    s_add_u32 s62, s62, 4096
    ds_read_b64_tr_b16 v[72:73], v10 offset:59392
    ds_read_b64_tr_b16 v[74:75], v10 offset:59904
    ds_read_b64_tr_b16 v[76:77], v11 offset:59392
    ds_read_b64_tr_b16 v[78:79], v11 offset:59904
    s_waitcnt lgkmcnt(4)
    s_waitcnt vmcnt(9)
    v_mfma_f32_32x32x16_bf16 v[32:47], v[64:67], v[128:131], v[32:47]
    v_mfma_f32_32x32x16_bf16 v[48:63], v[68:71], v[128:131], v[48:63]
    buffer_load_dwordx4 v[128:131], v27, s[20:23], s62 offen sc1
    s_add_u32 s62, s62, 4096
    ds_read_b64_tr_b16 v[64:65], v12 offset:6144
    ds_read_b64_tr_b16 v[66:67], v12 offset:6656
    ds_read_b64_tr_b16 v[68:69], v13 offset:6144
    ds_read_b64_tr_b16 v[70:71], v13 offset:6656
    s_waitcnt lgkmcnt(4)
    s_waitcnt vmcnt(8)
    v_mfma_f32_32x32x16_bf16 v[32:47], v[72:75], v[132:135], v[32:47]
    v_mfma_f32_32x32x16_bf16 v[48:63], v[76:79], v[132:135], v[48:63]
    buffer_load_dwordx4 v[132:135], v27, s[20:23], s62 offen sc1
    s_add_u32 s62, s62, 4096
    ds_read_b64_tr_b16 v[72:73], v12 offset:14336
    ds_read_b64_tr_b16 v[74:75], v12 offset:14848
    ds_read_b64_tr_b16 v[76:77], v13 offset:14336
    ds_read_b64_tr_b16 v[78:79], v13 offset:14848
    s_waitcnt lgkmcnt(4)
    s_waitcnt vmcnt(7)
    v_mfma_f32_32x32x16_bf16 v[32:47], v[64:67], v[136:139], v[32:47]
    v_mfma_f32_32x32x16_bf16 v[48:63], v[68:71], v[136:139], v[48:63]
    ds_read_b64_tr_b16 v[64:65], v12 offset:22528
    ds_read_b64_tr_b16 v[66:67], v12 offset:23040
    ds_read_b64_tr_b16 v[68:69], v13 offset:22528
    ds_read_b64_tr_b16 v[70:71], v13 offset:23040
    s_waitcnt lgkmcnt(4)
    s_waitcnt vmcnt(6)
    v_mfma_f32_32x32x16_bf16 v[32:47], v[72:75], v[140:143], v[32:47]
    v_mfma_f32_32x32x16_bf16 v[48:63], v[76:79], v[140:143], v[48:63]
    buffer_load_dword v30, off, s[20:23], s81 offset:512 sc1
    ds_read_b64_tr_b16 v[72:73], v12 offset:30720
    ds_read_b64_tr_b16 v[74:75], v12 offset:31232
    ds_read_b64_tr_b16 v[76:77], v13 offset:30720
    ds_read_b64_tr_b16 v[78:79], v13 offset:31232
    s_waitcnt lgkmcnt(4)
    s_waitcnt vmcnt(6)
    v_mfma_f32_32x32x16_bf16 v[32:47], v[64:67], v[112:115], v[32:47]
    v_mfma_f32_32x32x16_bf16 v[48:63], v[68:71], v[112:115], v[48:63]
    ds_read_b64_tr_b16 v[64:65], v12 offset:38912
    ds_read_b64_tr_b16 v[66:67], v12 offset:39424
    ds_read_b64_tr_b16 v[68:69], v13 offset:38912
    ds_read_b64_tr_b16 v[70:71], v13 offset:39424
    s_waitcnt lgkmcnt(4)
    s_waitcnt vmcnt(5)
    v_mfma_f32_32x32x16_bf16 v[32:47], v[72:75], v[116:119], v[32:47]
    v_mfma_f32_32x32x16_bf16 v[48:63], v[76:79], v[116:119], v[48:63]
    s_barrier
    ds_read_b64_tr_b16 v[72:73], v12 offset:47104
    ds_read_b64_tr_b16 v[74:75], v12 offset:47616
    ds_read_b64_tr_b16 v[76:77], v13 offset:47104
    ds_read_b64_tr_b16 v[78:79], v13 offset:47616
    s_waitcnt lgkmcnt(4)
    s_waitcnt vmcnt(4)
    v_mfma_f32_32x32x16_bf16 v[32:47], v[64:67], v[120:123], v[32:47]
    v_mfma_f32_32x32x16_bf16 v[48:63], v[68:71], v[120:123], v[48:63]
    ds_read_b64_tr_b16 v[64:65], v12 offset:55296
    ds_read_b64_tr_b16 v[66:67], v12 offset:55808
    ds_read_b64_tr_b16 v[68:69], v13 offset:55296
    ds_read_b64_tr_b16 v[70:71], v13 offset:55808
    s_waitcnt lgkmcnt(4)
    s_waitcnt vmcnt(3)
    v_mfma_f32_32x32x16_bf16 v[32:47], v[72:75], v[124:127], v[32:47]
    v_mfma_f32_32x32x16_bf16 v[48:63], v[76:79], v[124:127], v[48:63]
    ds_read_b64_tr_b16 v[72:73], v14 offset:2048
    ds_read_b64_tr_b16 v[74:75], v14 offset:2560
    ds_read_b64_tr_b16 v[76:77], v15 offset:2048
    ds_read_b64_tr_b16 v[78:79], v15 offset:2560
    s_waitcnt lgkmcnt(4)
    s_waitcnt vmcnt(2)
    v_mfma_f32_32x32x16_bf16 v[32:47], v[64:67], v[128:131], v[32:47]
    v_mfma_f32_32x32x16_bf16 v[48:63], v[68:71], v[128:131], v[48:63]
    s_waitcnt vmcnt(0)
    v_readfirstlane_b32 s68, v30
    s_nop 0
    s_cmp_lt_u32 s68, 8
    s_cbranch_scc1 PQNE
    buffer_load_dwordx4 v[224:227], v27, s[20:23], s63 offen sc1
    s_add_u32 s63, s63, 4096
    buffer_load_dwordx4 v[228:231], v27, s[20:23], s63 offen sc1
    s_add_u32 s63, s63, 4096
    buffer_load_dwordx4 v[232:235], v27, s[20:23], s63 offen sc1
    s_add_u32 s63, s63, 4096
    buffer_load_dwordx4 v[236:239], v27, s[20:23], s63 offen sc1
    s_add_u32 s63, s63, 4096
    buffer_load_dwordx4 v[240:243], v27, s[20:23], s63 offen sc1
    s_add_u32 s63, s63, 4096
    buffer_load_dwordx4 v[244:247], v27, s[20:23], s63 offen sc1
    s_add_u32 s63, s63, 4096
    buffer_load_dwordx4 v[248:251], v27, s[20:23], s63 offen sc1
    s_add_u32 s63, s63, 4096
    buffer_load_dwordx4 v[252:255], v27, s[20:23], s63 offen sc1
    s_add_u32 s63, s63, 4096
    s_branch PQE
PQNE:
    s_cmp_lg_u32 s58, 0
    s_cbranch_scc1 PQOI
    buffer_load_dword v30, off, s[20:23], s81 offset:512 sc1
PQOI:
PQE:
    s_cmp_ge_u32 s66, 2
    s_cbranch_scc1 PQR
    s_waitcnt lgkmcnt(0)
    v_mfma_f32_32x32x16_bf16 v[32:47], v[72:75], v[132:135], v[32:47]
    v_mfma_f32_32x32x16_bf16 v[48:63], v[76:79], v[132:135], v[48:63]
PQR:
    s_mul_i32 s64, s66, 16896
    s_mul_i32 s65, s67, 8448
    s_add_u32 s64, s64, s65
    v_add_u32 v6, s64, v27
    s_nop 6
    ds_write_b128 v6, v[32:35] offset:0
    ds_write_b128 v6, v[36:39] offset:1056
    ds_write_b128 v6, v[40:43] offset:2112
    ds_write_b128 v6, v[44:47] offset:3168
    ds_write_b128 v6, v[48:51] offset:4224
    ds_write_b128 v6, v[52:55] offset:5280
    ds_write_b128 v6, v[56:59] offset:6336
    ds_write_b128 v6, v[60:63] offset:7392
    s_mul_i32 s64, s60, 8448
    s_lshl_b32 s65, s59, 7
    s_add_u32 s64, s64, s65
    v_lshrrev_b32 v2, 3, v1
    v_and_b32 v4, 7, v1
    v_mul_u32_u24 v4, 1056, v4
    v_lshl_add_u32 v4, v2, 4, v4
    v_add_u32 v8, s64, v4
    v_add_u32 v16, 67584, v6
    v_add_u32 v17, 67584, v8
    v_lshlrev_b32 v144, 16, v108
    v_and_b32 v145, 0xffff0000, v108
    v_lshlrev_b32 v152, 16, v104
    v_and_b32 v153, 0xffff0000, v104
    v_lshlrev_b32 v146, 16, v109
    v_and_b32 v147, 0xffff0000, v109
    v_lshlrev_b32 v154, 16, v105
    v_and_b32 v155, 0xffff0000, v105
    v_lshlrev_b32 v148, 16, v110
    v_and_b32 v149, 0xffff0000, v110
    v_lshlrev_b32 v156, 16, v106
    v_and_b32 v157, 0xffff0000, v106
    v_lshlrev_b32 v150, 16, v111
    v_and_b32 v151, 0xffff0000, v111
    v_lshlrev_b32 v158, 16, v107
    v_and_b32 v159, 0xffff0000, v107
    s_cmp_lt_u32 s68, 8
    s_cbranch_scc1 PQLT
    s_waitcnt vmcnt(7)
    v_mfma_f32_32x32x16_bf16 v[112:127], v[160:163], v[224:227], 0
    v_mfma_f32_32x32x16_bf16 v[128:143], v[164:167], v[224:227], 0
    s_waitcnt vmcnt(6)
    v_mfma_f32_32x32x16_bf16 v[112:127], v[168:171], v[228:231], v[112:127]
    v_mfma_f32_32x32x16_bf16 v[128:143], v[172:175], v[228:231], v[128:143]
    s_waitcnt vmcnt(5)
    v_mfma_f32_32x32x16_bf16 v[112:127], v[176:179], v[232:235], v[112:127]
    v_mfma_f32_32x32x16_bf16 v[128:143], v[180:183], v[232:235], v[128:143]
    s_waitcnt vmcnt(4)
    v_mfma_f32_32x32x16_bf16 v[112:127], v[184:187], v[236:239], v[112:127]
    v_mfma_f32_32x32x16_bf16 v[128:143], v[188:191], v[236:239], v[128:143]
    s_waitcnt vmcnt(3)
    v_mfma_f32_32x32x16_bf16 v[112:127], v[192:195], v[240:243], v[112:127]
    v_mfma_f32_32x32x16_bf16 v[128:143], v[196:199], v[240:243], v[128:143]
    s_waitcnt vmcnt(2)
    v_mfma_f32_32x32x16_bf16 v[112:127], v[200:203], v[244:247], v[112:127]
    v_mfma_f32_32x32x16_bf16 v[128:143], v[204:207], v[244:247], v[128:143]
    s_waitcnt vmcnt(1)
    v_mfma_f32_32x32x16_bf16 v[112:127], v[208:211], v[248:251], v[112:127]
    v_mfma_f32_32x32x16_bf16 v[128:143], v[212:215], v[248:251], v[128:143]
    s_waitcnt vmcnt(0)
    v_mfma_f32_32x32x16_bf16 v[112:127], v[216:219], v[252:255], v[112:127]
    v_mfma_f32_32x32x16_bf16 v[128:143], v[220:223], v[252:255], v[128:143]
    s_waitcnt lgkmcnt(0)
    s_barrier
    ds_read_b128 v[64:67], v8 offset:0
    ds_read_b128 v[68:71], v8 offset:512
    ds_read_b128 v[72:75], v8 offset:16896
    ds_read_b128 v[76:79], v8 offset:17408
    ds_read_b128 v[80:83], v8 offset:33792
    ds_read_b128 v[84:87], v8 offset:34304
    ds_read_b128 v[88:91], v8 offset:50688
    ds_read_b128 v[92:95], v8 offset:51200
    s_nop 0
    ds_write_b128 v16, v[112:115] offset:0
    ds_write_b128 v16, v[116:119] offset:1056
    ds_write_b128 v16, v[120:123] offset:2112
    ds_write_b128 v16, v[124:127] offset:3168
    ds_write_b128 v16, v[128:131] offset:4224
    ds_write_b128 v16, v[132:135] offset:5280
    ds_write_b128 v16, v[136:139] offset:6336
    ds_write_b128 v16, v[140:143] offset:7392
    s_waitcnt lgkmcnt(12)
    v_pk_add_f32 v[64:65], v[64:65], v[72:73]
    v_pk_add_f32 v[66:67], v[66:67], v[74:75]
    v_pk_add_f32 v[68:69], v[68:69], v[76:77]
    v_pk_add_f32 v[70:71], v[70:71], v[78:79]
    s_waitcnt lgkmcnt(8)
    v_pk_add_f32 v[80:81], v[80:81], v[88:89]
    v_pk_add_f32 v[82:83], v[82:83], v[90:91]
    v_pk_add_f32 v[84:85], v[84:85], v[92:93]
    v_pk_add_f32 v[86:87], v[86:87], v[94:95]
    v_pk_add_f32 v[96:97], v[64:65], v[80:81]
    v_pk_add_f32 v[98:99], v[66:67], v[82:83]
    v_pk_add_f32 v[100:101], v[68:69], v[84:85]
    v_pk_add_f32 v[102:103], v[70:71], v[86:87]
    v_pk_add_f32 v[96:97], v[96:97], v[144:145]
    v_pk_add_f32 v[98:99], v[98:99], v[146:147]
    v_pk_add_f32 v[100:101], v[100:101], v[148:149]
    v_pk_add_f32 v[102:103], v[102:103], v[150:151]
    v_mul_f32 v144, 0xbfb8aa3b, v96
    v_mul_f32 v145, 0xbfb8aa3b, v97
    v_mul_f32 v146, 0xbfb8aa3b, v98
    v_mul_f32 v147, 0xbfb8aa3b, v99
    v_mul_f32 v148, 0xbfb8aa3b, v100
    v_mul_f32 v149, 0xbfb8aa3b, v101
    v_mul_f32 v150, 0xbfb8aa3b, v102
    v_mul_f32 v151, 0xbfb8aa3b, v103
    v_exp_f32 v144, v144
    v_exp_f32 v145, v145
    v_exp_f32 v146, v146
    v_exp_f32 v147, v147
    v_exp_f32 v148, v148
    v_exp_f32 v149, v149
    v_exp_f32 v150, v150
    v_exp_f32 v151, v151
    v_add_f32 v144, 1.0, v144
    v_add_f32 v145, 1.0, v145
    v_add_f32 v146, 1.0, v146
    v_add_f32 v147, 1.0, v147
    v_add_f32 v148, 1.0, v148
    v_add_f32 v149, 1.0, v149
    v_add_f32 v150, 1.0, v150
    v_add_f32 v151, 1.0, v151
    v_rcp_f32 v144, v144
    v_rcp_f32 v145, v145
    v_rcp_f32 v146, v146
    v_rcp_f32 v147, v147
    v_rcp_f32 v148, v148
    v_rcp_f32 v149, v149
    v_rcp_f32 v150, v150
    v_rcp_f32 v151, v151
    v_pk_mul_f32 v[96:97], v[96:97], v[144:145]
    v_pk_mul_f32 v[98:99], v[98:99], v[146:147]
    v_pk_mul_f32 v[100:101], v[100:101], v[148:149]
    v_pk_mul_f32 v[102:103], v[102:103], v[150:151]
    s_barrier
    s_branch PQFN
PQLT:
    s_waitcnt lgkmcnt(0)
    s_barrier
    ds_read_b128 v[64:67], v8 offset:0
    ds_read_b128 v[68:71], v8 offset:512
    ds_read_b128 v[72:75], v8 offset:16896
    ds_read_b128 v[76:79], v8 offset:17408
    ds_read_b128 v[80:83], v8 offset:33792
    ds_read_b128 v[84:87], v8 offset:34304
    ds_read_b128 v[88:91], v8 offset:50688
    ds_read_b128 v[92:95], v8 offset:51200
    s_waitcnt lgkmcnt(4)
    v_pk_add_f32 v[64:65], v[64:65], v[72:73]
    v_pk_add_f32 v[66:67], v[66:67], v[74:75]
    v_pk_add_f32 v[68:69], v[68:69], v[76:77]
    v_pk_add_f32 v[70:71], v[70:71], v[78:79]
    s_waitcnt lgkmcnt(0)
    v_pk_add_f32 v[80:81], v[80:81], v[88:89]
    v_pk_add_f32 v[82:83], v[82:83], v[90:91]
    v_pk_add_f32 v[84:85], v[84:85], v[92:93]
    v_pk_add_f32 v[86:87], v[86:87], v[94:95]
    v_pk_add_f32 v[96:97], v[64:65], v[80:81]
    v_pk_add_f32 v[98:99], v[66:67], v[82:83]
    v_pk_add_f32 v[100:101], v[68:69], v[84:85]
    v_pk_add_f32 v[102:103], v[70:71], v[86:87]
    v_pk_add_f32 v[96:97], v[96:97], v[144:145]
    v_pk_add_f32 v[98:99], v[98:99], v[146:147]
    v_pk_add_f32 v[100:101], v[100:101], v[148:149]
    v_pk_add_f32 v[102:103], v[102:103], v[150:151]
    v_mul_f32 v144, 0xbfb8aa3b, v96
    v_mul_f32 v145, 0xbfb8aa3b, v97
    v_mul_f32 v146, 0xbfb8aa3b, v98
    v_mul_f32 v147, 0xbfb8aa3b, v99
    v_mul_f32 v148, 0xbfb8aa3b, v100
    v_mul_f32 v149, 0xbfb8aa3b, v101
    v_mul_f32 v150, 0xbfb8aa3b, v102
    v_mul_f32 v151, 0xbfb8aa3b, v103
    v_exp_f32 v144, v144
    v_exp_f32 v145, v145
    v_exp_f32 v146, v146
    v_exp_f32 v147, v147
    v_exp_f32 v148, v148
    v_exp_f32 v149, v149
    v_exp_f32 v150, v150
    v_exp_f32 v151, v151
    v_add_f32 v144, 1.0, v144
    v_add_f32 v145, 1.0, v145
    v_add_f32 v146, 1.0, v146
    v_add_f32 v147, 1.0, v147
    v_add_f32 v148, 1.0, v148
    v_add_f32 v149, 1.0, v149
    v_add_f32 v150, 1.0, v150
    v_add_f32 v151, 1.0, v151
    v_rcp_f32 v144, v144
    v_rcp_f32 v145, v145
    v_rcp_f32 v146, v146
    v_rcp_f32 v147, v147
    v_rcp_f32 v148, v148
    v_rcp_f32 v149, v149
    v_rcp_f32 v150, v150
    v_rcp_f32 v151, v151
    v_pk_mul_f32 v[96:97], v[96:97], v[144:145]
    v_pk_mul_f32 v[98:99], v[98:99], v[146:147]
    v_pk_mul_f32 v[100:101], v[100:101], v[148:149]
    v_pk_mul_f32 v[102:103], v[102:103], v[150:151]
    s_waitcnt vmcnt(0)
    s_cmp_lg_u32 s58, 0
    s_cbranch_scc1 PQOD
    s_mov_b32 s80, 400000
PQO:
    v_readfirstlane_b32 s65, v30
    s_nop 0
    s_cmp_ge_u32 s65, 8
    s_cbranch_scc1 PQOD
    s_sub_u32 s80, s80, 1
    s_cbranch_scc1 PQOD
    buffer_load_dword v30, off, s[20:23], s81 offset:512 sc1
    s_waitcnt vmcnt(0)
    s_branch PQO
PQOD:
    s_barrier
    buffer_load_dwordx4 v[224:227], v27, s[20:23], s63 offen sc1
    s_add_u32 s63, s63, 4096
    buffer_load_dwordx4 v[228:231], v27, s[20:23], s63 offen sc1
    s_add_u32 s63, s63, 4096
    buffer_load_dwordx4 v[232:235], v27, s[20:23], s63 offen sc1
    s_add_u32 s63, s63, 4096
    buffer_load_dwordx4 v[236:239], v27, s[20:23], s63 offen sc1
    s_add_u32 s63, s63, 4096
    buffer_load_dwordx4 v[240:243], v27, s[20:23], s63 offen sc1
    s_add_u32 s63, s63, 4096
    buffer_load_dwordx4 v[244:247], v27, s[20:23], s63 offen sc1
    s_add_u32 s63, s63, 4096
    buffer_load_dwordx4 v[248:251], v27, s[20:23], s63 offen sc1
    s_add_u32 s63, s63, 4096
    buffer_load_dwordx4 v[252:255], v27, s[20:23], s63 offen sc1
    s_add_u32 s63, s63, 4096
    s_waitcnt vmcnt(7)
    v_mfma_f32_32x32x16_bf16 v[112:127], v[160:163], v[224:227], 0
    v_mfma_f32_32x32x16_bf16 v[128:143], v[164:167], v[224:227], 0
    s_waitcnt vmcnt(6)
    v_mfma_f32_32x32x16_bf16 v[112:127], v[168:171], v[228:231], v[112:127]
    v_mfma_f32_32x32x16_bf16 v[128:143], v[172:175], v[228:231], v[128:143]
    s_waitcnt vmcnt(5)
    v_mfma_f32_32x32x16_bf16 v[112:127], v[176:179], v[232:235], v[112:127]
    v_mfma_f32_32x32x16_bf16 v[128:143], v[180:183], v[232:235], v[128:143]
    s_waitcnt vmcnt(4)
    v_mfma_f32_32x32x16_bf16 v[112:127], v[184:187], v[236:239], v[112:127]
    v_mfma_f32_32x32x16_bf16 v[128:143], v[188:191], v[236:239], v[128:143]
    s_waitcnt vmcnt(3)
    v_mfma_f32_32x32x16_bf16 v[112:127], v[192:195], v[240:243], v[112:127]
    v_mfma_f32_32x32x16_bf16 v[128:143], v[196:199], v[240:243], v[128:143]
    s_waitcnt vmcnt(2)
    v_mfma_f32_32x32x16_bf16 v[112:127], v[200:203], v[244:247], v[112:127]
    v_mfma_f32_32x32x16_bf16 v[128:143], v[204:207], v[244:247], v[128:143]
    s_waitcnt vmcnt(1)
    v_mfma_f32_32x32x16_bf16 v[112:127], v[208:211], v[248:251], v[112:127]
    v_mfma_f32_32x32x16_bf16 v[128:143], v[212:215], v[248:251], v[128:143]
    s_waitcnt vmcnt(0)
    v_mfma_f32_32x32x16_bf16 v[112:127], v[216:219], v[252:255], v[112:127]
    v_mfma_f32_32x32x16_bf16 v[128:143], v[220:223], v[252:255], v[128:143]
    s_nop 10
    ds_write_b128 v16, v[112:115] offset:0
    ds_write_b128 v16, v[116:119] offset:1056
    ds_write_b128 v16, v[120:123] offset:2112
    ds_write_b128 v16, v[124:127] offset:3168
    ds_write_b128 v16, v[128:131] offset:4224
    ds_write_b128 v16, v[132:135] offset:5280
    ds_write_b128 v16, v[136:139] offset:6336
    ds_write_b128 v16, v[140:143] offset:7392
PQFN:
    s_waitcnt lgkmcnt(0)
    s_barrier
    ds_read_b128 v[64:67], v17 offset:0
    ds_read_b128 v[68:71], v17 offset:512
    ds_read_b128 v[72:75], v17 offset:16896
    ds_read_b128 v[76:79], v17 offset:17408
    ds_read_b128 v[80:83], v17 offset:33792
    ds_read_b128 v[84:87], v17 offset:34304
    ds_read_b128 v[88:91], v17 offset:50688
    ds_read_b128 v[92:95], v17 offset:51200
    s_waitcnt lgkmcnt(4)
    v_pk_add_f32 v[64:65], v[64:65], v[72:73]
    v_pk_add_f32 v[66:67], v[66:67], v[74:75]
    v_pk_add_f32 v[68:69], v[68:69], v[76:77]
    v_pk_add_f32 v[70:71], v[70:71], v[78:79]
    s_waitcnt lgkmcnt(0)
    v_pk_add_f32 v[80:81], v[80:81], v[88:89]
    v_pk_add_f32 v[82:83], v[82:83], v[90:91]
    v_pk_add_f32 v[84:85], v[84:85], v[92:93]
    v_pk_add_f32 v[86:87], v[86:87], v[94:95]
    v_pk_add_f32 v[64:65], v[64:65], v[80:81]
    v_pk_add_f32 v[66:67], v[66:67], v[82:83]
    v_pk_add_f32 v[68:69], v[68:69], v[84:85]
    v_pk_add_f32 v[70:71], v[70:71], v[86:87]
    v_pk_fma_f32 v[152:153], v[64:65], v[96:97], v[152:153]
    v_pk_fma_f32 v[154:155], v[66:67], v[98:99], v[154:155]
    v_pk_fma_f32 v[156:157], v[68:69], v[100:101], v[156:157]
    v_pk_fma_f32 v[158:159], v[70:71], v[102:103], v[158:159]
    v_cvt_pk_bf16_f32 v104, v152, v153
    v_cvt_pk_bf16_f32 v105, v154, v155
    v_cvt_pk_bf16_f32 v106, v156, v157
    v_cvt_pk_bf16_f32 v107, v158, v159
    buffer_store_dwordx4 v[104:107], v7, s[16:19], s71 offen
    s_branch K1_END
K1_MLP:
    s_sub_u32 s77, s57, 8
    s_mul_i32 s65, s77, 384
    s_sub_u32 s64, 1409024, s65
    s_add_u32 s8, s42, s65
    s_addc_u32 s9, s43, 0
    s_mov_b32 s10, s64
    s_mov_b32 s11, 0x00020000
    s_add_u32 s65, s65, 128
    s_sub_u32 s64, 1409024, s65
    s_add_u32 s12, s42, s65
    s_addc_u32 s13, s43, 0
    s_mov_b32 s14, s64
    s_mov_b32 s15, 0x00020000
    s_add_u32 s65, s65, 128
    s_sub_u32 s64, 1409024, s65
    s_add_u32 s16, s42, s65
    s_addc_u32 s17, s43, 0
    s_mov_b32 s18, s64
    s_mov_b32 s19, 0x00020000
    s_add_u32 s74, s83, 0
    s_and_b32 s74, s74, 7
    s_lshl_b32 s71, s74, 7
    s_mul_i32 s72, s74, s61
    s_mul_i32 s73, s74, s62
    s_add_u32 m0, s66, 0
    s_nop 0
    buffer_load_dwordx4 v6, s[4:7], s71 offen offset:0 lds
    s_add_u32 m0, s66, 0
    s_nop 0
    buffer_load_dwordx4 v7, s[4:7], s71 offen offset:1024 lds
    s_add_u32 m0, s67, 0
    s_nop 0
    buffer_load_dwordx4 v8, s[8:11], s72 offen lds
    s_add_u32 m0, s67, 8192
    s_nop 0
    buffer_load_dwordx4 v9, s[12:15], s73 offen lds
    s_add_u32 m0, s67, 16384
    s_nop 0
    buffer_load_dwordx4 v9, s[16:19], s73 offen lds
    s_add_u32 s74, s83, 1
    s_and_b32 s74, s74, 7
    s_lshl_b32 s71, s74, 7
    s_mul_i32 s72, s74, s61
    s_mul_i32 s73, s74, s62
    s_add_u32 m0, s66, 16384
    s_nop 0
    buffer_load_dwordx4 v6, s[4:7], s71 offen offset:0 lds
    s_add_u32 m0, s66, 16384
    s_nop 0
    buffer_load_dwordx4 v7, s[4:7], s71 offen offset:1024 lds
    s_add_u32 m0, s67, 24576
    s_nop 0
    buffer_load_dwordx4 v8, s[8:11], s72 offen lds
    s_add_u32 m0, s67, 32768
    s_nop 0
    buffer_load_dwordx4 v9, s[12:15], s73 offen lds
    s_add_u32 m0, s67, 40960
    s_nop 0
    buffer_load_dwordx4 v9, s[16:19], s73 offen lds
    s_add_u32 s24, s44, 0
    s_addc_u32 s25, s45, 0
    s_mov_b32 s26, 2752
    s_mov_b32 s27, 0x00020000
    s_lshr_b32 s64, s58, 1
    s_lshl_b32 s64, s64, 4
    s_and_b32 s65, s58, 1
    s_lshl_b32 s65, s65, 2
    s_add_u32 s64, s64, s65
    v_lshrrev_b32 v2, 5, v1
    v_bfe_u32 v4, v1, 3, 2
    v_lshl_add_u32 v2, v2, 3, v4
    v_add_u32 v2, s64, v2
    v_lshl_add_u32 v26, v2, 10, v3
    v_lshlrev_b32 v27, 4, v1
    s_lshl_b32 s75, s57, 2
    s_xor_b32 s76, s56, s57
    s_or_b32 s76, s76, s58
    s_cmp_lg_u32 s76, 0
    s_cbranch_scc1 K1_Z0
    s_mul_i32 s64, s57, 10240
    s_add_u32 s64, s64, 10485760
    v_mov_b32 v132, 0
    v_mov_b32 v133, 0
    v_mov_b32 v134, 0
    v_mov_b32 v135, 0
    buffer_store_dwordx4 v[132:135], v27, s[20:23], s64 offen offset:0 sc1
    buffer_store_dwordx4 v[132:135], v27, s[20:23], s64 offen offset:1024 sc1
    buffer_store_dwordx4 v[132:135], v27, s[20:23], s64 offen offset:2048 sc1
    buffer_store_dwordx4 v[132:135], v27, s[20:23], s64 offen offset:3072 sc1
    s_add_u32 s64, s64, 4096
    buffer_store_dwordx4 v[132:135], v27, s[20:23], s64 offen offset:0 sc1
    buffer_store_dwordx4 v[132:135], v27, s[20:23], s64 offen offset:1024 sc1
    buffer_store_dwordx4 v[132:135], v27, s[20:23], s64 offen offset:2048 sc1
    buffer_store_dwordx4 v[132:135], v27, s[20:23], s64 offen offset:3072 sc1
    s_add_u32 s64, s64, 4096
    buffer_store_dwordx4 v[132:135], v27, s[20:23], s64 offen offset:0 sc1
    buffer_store_dwordx4 v[132:135], v27, s[20:23], s64 offen offset:1024 sc1
K1_Z0:
    s_lshl_b32 s69, s60, 1
    s_xor_b32 s69, s69, s59
    v_and_b32 v29, 31, v1
    v_lshrrev_b32 v28, 5, v1
    s_lshl_b32 s65, s59, 12
    v_lshrrev_b32 v2, 1, v29
    v_and_b32 v2, 7, v2
    v_xor_b32 v2, v2, v28
    v_lshlrev_b32 v3, 7, v29
    v_add_u32 v3, s65, v3
    s_xor_b32 s65, s69, 0
    s_lshl_b32 s65, s65, 1
    v_xor_b32 v4, s65, v2
    v_lshl_add_u32 v10, v4, 4, v3
    s_xor_b32 s65, s69, 1
    s_lshl_b32 s65, s65, 1
    v_xor_b32 v4, s65, v2
    v_lshl_add_u32 v11, v4, 4, v3
    s_xor_b32 s65, s69, 2
    s_lshl_b32 s65, s65, 1
    v_xor_b32 v4, s65, v2
    v_lshl_add_u32 v12, v4, 4, v3
    s_xor_b32 s65, s69, 3
    s_lshl_b32 s65, s65, 1
    v_xor_b32 v4, s65, v2
    v_lshl_add_u32 v13, v4, 4, v3
    v_bfe_u32 v2, v1, 2, 2
    v_lshl_add_u32 v3, v28, 3, v2
    v_lshlrev_b32 v3, 7, v3
    v_bfe_u32 v4, v1, 4, 1
    v_lshlrev_b32 v4, 1, v4
    v_bfe_u32 v5, v1, 1, 1
    v_or_b32 v4, v4, v5
    v_bfe_u32 v5, v1, 3, 1
    v_xor_b32 v5, s60, v5
    v_lshl_or_b32 v4, v5, 2, v4
    v_lshl_add_u32 v3, v4, 4, v3
    v_and_b32 v5, 1, v1
    v_lshl_add_u32 v3, v5, 3, v3
    s_xor_b32 s65, s69, 0
    s_lshl_b32 s65, s65, 11
    s_add_u32 s65, s65, 0x10000
    v_add_u32 v14, s65, v3
    v_add_u32 v18, 49152, v14
    s_xor_b32 s65, s69, 1
    s_lshl_b32 s65, s65, 11
    s_add_u32 s65, s65, 0x10000
    v_add_u32 v15, s65, v3
    v_add_u32 v19, 49152, v15
    s_xor_b32 s65, s69, 2
    s_lshl_b32 s65, s65, 11
    s_add_u32 s65, s65, 0x10000
    v_add_u32 v16, s65, v3
    v_add_u32 v20, 49152, v16
    s_xor_b32 s65, s69, 3
    s_lshl_b32 s65, s65, 11
    s_add_u32 s65, s65, 0x10000
    v_add_u32 v17, s65, v3
    v_add_u32 v21, 49152, v17
    v_mov_b32 v22, 0
    v_mov_b32 v23, 0
    v_mov_b32 v24, 0
    v_mov_b32 v25, 0
    v_bfe_u32 v2, v1, 4, 1
    v_bfe_u32 v3, v1, 2, 1
    v_cmp_eq_u32 vcc, v2, v3
    v_mov_b32 v2, s70
    s_nop 0
    v_cndmask_b32 v240, 0, v2, vcc
    v_cndmask_b32 v241, 0, v2, vcc
    v_cndmask_b32 v242, 0, v2, vcc
    v_cndmask_b32 v243, 0, v2, vcc
    s_mul_i32 s64, s77, 384
    s_lshl_b32 s65, s60, 6
    s_add_u32 s64, s64, s65
    v_lshl_add_u32 v2, v29, 1, s64
    v_mov_b32 v112, 0
    v_mov_b32 v113, 0
    v_mov_b32 v114, 0
    buffer_load_short_d16_hi v112, v2, s[24:27], 0 offen offset:0
    buffer_load_short_d16_hi v113, v2, s[24:27], 0 offen offset:128
    buffer_load_short_d16_hi v114, v2, s[24:27], 0 offen offset:256
    s_cmp_lt_u32 s2, 236
    s_cselect_b32 s26, 8192, 0
    s_sub_u32 s65, s2, 172
    s_cselect_b32 s24, s46, s38
    s_cselect_b32 s25, s47, s39
    s_cselect_b32 s64, s2, s65
    s_lshl_b32 s64, s64, 13
    s_add_u32 s24, s24, s64
    s_addc_u32 s25, s25, 0
    v_lshlrev_b32 v31, 4, v0
    buffer_load_dword v30, v31, s[24:27], 0 offen
    s_waitcnt vmcnt(9)
    s_barrier
    ds_read_b128 v[32:35], v10 offset:0
    ds_read_b64_tr_b16 v[36:37], v14 offset:0
    ds_read_b64_tr_b16 v[38:39], v14 offset:512
    ds_read_b64_tr_b16 v[40:41], v14 offset:8192
    ds_read_b64_tr_b16 v[42:43], v14 offset:8704
    ds_read_b64_tr_b16 v[44:45], v14 offset:16384
    ds_read_b64_tr_b16 v[46:47], v14 offset:16896
    s_add_u32 s74, s83, 2
    s_and_b32 s74, s74, 7
    s_lshl_b32 s71, s74, 7
    s_mul_i32 s72, s74, s61
    s_mul_i32 s73, s74, s62
    s_add_u32 m0, s66, 32768
    s_nop 0
    buffer_load_dwordx4 v6, s[4:7], s71 offen offset:0 lds
    s_add_u32 m0, s66, 32768
    s_nop 0
    buffer_load_dwordx4 v7, s[4:7], s71 offen offset:1024 lds
    s_waitcnt lgkmcnt(0)
    v_mfma_f32_32x32x16_bf16 v[64:79], v[36:39], v[32:35], 0
    ds_read_b128 v[48:51], v11 offset:0
    ds_read_b64_tr_b16 v[52:53], v15 offset:0
    ds_read_b64_tr_b16 v[54:55], v15 offset:512
    ds_read_b64_tr_b16 v[56:57], v15 offset:8192
    ds_read_b64_tr_b16 v[58:59], v15 offset:8704
    ds_read_b64_tr_b16 v[60:61], v15 offset:16384
    ds_read_b64_tr_b16 v[62:63], v15 offset:16896
    v_lshlrev_b32 v2, 16, v32
    v_and_b32 v3, 0xffff0000, v32
    v_add_f32 v22, v22, v2
    v_fmac_f32 v23, v2, v2
    v_mfma_f32_32x32x16_bf16 v[80:95], v[40:43], v[32:35], 0
    s_add_u32 m0, s67, 49152
    s_nop 0
    buffer_load_dwordx4 v8, s[8:11], s72 offen lds
    v_add_f32 v24, v24, v3
    v_fmac_f32 v25, v3, v3
    v_lshlrev_b32 v4, 16, v33
    v_and_b32 v5, 0xffff0000, v33
    v_mfma_f32_32x32x16_bf16 v[96:111], v[44:47], v[32:35], 0
    v_add_f32 v22, v22, v4
    v_fmac_f32 v23, v4, v4
    v_add_f32 v24, v24, v5
    v_fmac_f32 v25, v5, v5
    s_waitcnt lgkmcnt(0)
    v_mfma_f32_32x32x16_bf16 v[64:79], v[52:55], v[48:51], v[64:79]
    ds_read_b128 v[232:235], v12 offset:0
    ds_read_b64_tr_b16 v[36:37], v16 offset:0
    ds_read_b64_tr_b16 v[38:39], v16 offset:512
    ds_read_b64_tr_b16 v[40:41], v16 offset:8192
    ds_read_b64_tr_b16 v[42:43], v16 offset:8704
    ds_read_b64_tr_b16 v[44:45], v16 offset:16384
    ds_read_b64_tr_b16 v[46:47], v16 offset:16896
    v_lshlrev_b32 v2, 16, v34
    v_and_b32 v3, 0xffff0000, v34
    v_add_f32 v22, v22, v2
    v_fmac_f32 v23, v2, v2
    v_mfma_f32_16x16x32_bf16 v[244:247], v[240:243], v[52:55], 0
    v_mfma_f32_32x32x16_bf16 v[80:95], v[56:59], v[48:51], v[80:95]
    s_add_u32 m0, s67, 57344
    s_nop 0
    buffer_load_dwordx4 v9, s[12:15], s73 offen lds
    v_add_f32 v24, v24, v3
    v_fmac_f32 v25, v3, v3
    v_lshlrev_b32 v4, 16, v35
    v_and_b32 v5, 0xffff0000, v35
    v_mfma_f32_32x32x16_bf16 v[96:111], v[60:63], v[48:51], v[96:111]
    v_add_f32 v22, v22, v4
    v_fmac_f32 v23, v4, v4
    v_add_f32 v24, v24, v5
    v_fmac_f32 v25, v5, v5
    s_waitcnt lgkmcnt(0)
    v_mfma_f32_32x32x16_bf16 v[64:79], v[36:39], v[232:235], v[64:79]
    ds_read_b128 v[236:239], v13 offset:0
    ds_read_b64_tr_b16 v[52:53], v17 offset:0
    ds_read_b64_tr_b16 v[54:55], v17 offset:512
    ds_read_b64_tr_b16 v[56:57], v17 offset:8192
    ds_read_b64_tr_b16 v[58:59], v17 offset:8704
    ds_read_b64_tr_b16 v[60:61], v17 offset:16384
    ds_read_b64_tr_b16 v[62:63], v17 offset:16896
    v_lshlrev_b32 v2, 16, v48
    v_and_b32 v3, 0xffff0000, v48
    v_add_f32 v22, v22, v2
    v_fmac_f32 v23, v2, v2
    v_mfma_f32_32x32x16_bf16 v[80:95], v[40:43], v[232:235], v[80:95]
    s_add_u32 m0, s67, 65536
    s_nop 0
    buffer_load_dwordx4 v9, s[16:19], s73 offen lds
    v_add_f32 v24, v24, v3
    v_fmac_f32 v25, v3, v3
    v_lshlrev_b32 v4, 16, v49
    v_and_b32 v5, 0xffff0000, v49
    v_mfma_f32_32x32x16_bf16 v[96:111], v[44:47], v[232:235], v[96:111]
    v_add_f32 v22, v22, v4
    v_fmac_f32 v23, v4, v4
    v_add_f32 v24, v24, v5
    v_fmac_f32 v25, v5, v5
    v_mfma_f32_16x16x32_bf16 v[252:255], v[240:243], v[44:47], 0
    s_waitcnt lgkmcnt(0)
    v_mfma_f32_32x32x16_bf16 v[64:79], v[52:55], v[236:239], v[64:79]
    s_waitcnt vmcnt(9)
    s_barrier
    ds_read_b128 v[32:35], v10 offset:16384
    ds_read_b64_tr_b16 v[36:37], v14 offset:24576
    ds_read_b64_tr_b16 v[38:39], v14 offset:25088
    ds_read_b64_tr_b16 v[40:41], v14 offset:32768
    ds_read_b64_tr_b16 v[42:43], v14 offset:33280
    ds_read_b64_tr_b16 v[44:45], v14 offset:40960
    ds_read_b64_tr_b16 v[46:47], v14 offset:41472
    v_lshlrev_b32 v2, 16, v50
    v_and_b32 v3, 0xffff0000, v50
    v_add_f32 v22, v22, v2
    v_fmac_f32 v23, v2, v2
    v_mfma_f32_32x32x16_bf16 v[80:95], v[56:59], v[236:239], v[80:95]
    s_add_u32 s74, s83, 3
    s_and_b32 s74, s74, 7
    s_lshl_b32 s71, s74, 7
    s_mul_i32 s72, s74, s61
    s_mul_i32 s73, s74, s62
    s_add_u32 m0, s66, 49152
    s_nop 0
    buffer_load_dwordx4 v6, s[4:7], s71 offen offset:0 lds
    v_add_f32 v24, v24, v3
    v_fmac_f32 v25, v3, v3
    v_lshlrev_b32 v4, 16, v51
    v_and_b32 v5, 0xffff0000, v51
    v_mfma_f32_16x16x32_bf16 v[248:251], v[240:243], v[56:59], 0
    v_mfma_f32_32x32x16_bf16 v[96:111], v[60:63], v[236:239], v[96:111]
    s_add_u32 m0, s66, 49152
    s_nop 0
    buffer_load_dwordx4 v7, s[4:7], s71 offen offset:1024 lds
    v_add_f32 v22, v22, v4
    v_fmac_f32 v23, v4, v4
    v_add_f32 v24, v24, v5
    v_fmac_f32 v25, v5, v5
    s_waitcnt lgkmcnt(0)
    v_mfma_f32_32x32x16_bf16 v[64:79], v[36:39], v[32:35], v[64:79]
    ds_read_b128 v[48:51], v11 offset:16384
    ds_read_b64_tr_b16 v[52:53], v15 offset:24576
    ds_read_b64_tr_b16 v[54:55], v15 offset:25088
    ds_read_b64_tr_b16 v[56:57], v15 offset:32768
    ds_read_b64_tr_b16 v[58:59], v15 offset:33280
    ds_read_b64_tr_b16 v[60:61], v15 offset:40960
    ds_read_b64_tr_b16 v[62:63], v15 offset:41472
    v_lshlrev_b32 v2, 16, v32
    v_and_b32 v3, 0xffff0000, v32
    v_add_f32 v22, v22, v2
    v_fmac_f32 v23, v2, v2
    v_mfma_f32_32x32x16_bf16 v[80:95], v[40:43], v[32:35], v[80:95]
    s_add_u32 m0, s67, 73728
    s_nop 0
    buffer_load_dwordx4 v8, s[8:11], s72 offen lds
    v_add_f32 v24, v24, v3
    v_fmac_f32 v25, v3, v3
    v_lshlrev_b32 v4, 16, v33
    v_and_b32 v5, 0xffff0000, v33
    v_mfma_f32_32x32x16_bf16 v[96:111], v[44:47], v[32:35], v[96:111]
    v_add_f32 v22, v22, v4
    v_fmac_f32 v23, v4, v4
    v_add_f32 v24, v24, v5
    v_fmac_f32 v25, v5, v5
    s_waitcnt lgkmcnt(0)
    v_mfma_f32_32x32x16_bf16 v[64:79], v[52:55], v[48:51], v[64:79]
    ds_read_b128 v[232:235], v12 offset:16384
    ds_read_b64_tr_b16 v[36:37], v16 offset:24576
    ds_read_b64_tr_b16 v[38:39], v16 offset:25088
    ds_read_b64_tr_b16 v[40:41], v16 offset:32768
    ds_read_b64_tr_b16 v[42:43], v16 offset:33280
    ds_read_b64_tr_b16 v[44:45], v16 offset:40960
    ds_read_b64_tr_b16 v[46:47], v16 offset:41472
    v_lshlrev_b32 v2, 16, v34
    v_and_b32 v3, 0xffff0000, v34
    v_add_f32 v22, v22, v2
    v_fmac_f32 v23, v2, v2
    v_mfma_f32_16x16x32_bf16 v[244:247], v[240:243], v[52:55], v[244:247]
    v_mfma_f32_32x32x16_bf16 v[80:95], v[56:59], v[48:51], v[80:95]
    s_add_u32 m0, s67, 81920
    s_nop 0
    buffer_load_dwordx4 v9, s[12:15], s73 offen lds
    v_add_f32 v24, v24, v3
    v_fmac_f32 v25, v3, v3
    v_lshlrev_b32 v4, 16, v35
    v_and_b32 v5, 0xffff0000, v35
    v_mfma_f32_32x32x16_bf16 v[96:111], v[60:63], v[48:51], v[96:111]
    v_add_f32 v22, v22, v4
    v_fmac_f32 v23, v4, v4
    v_add_f32 v24, v24, v5
    v_fmac_f32 v25, v5, v5
    s_waitcnt lgkmcnt(0)
    v_mfma_f32_32x32x16_bf16 v[64:79], v[36:39], v[232:235], v[64:79]
    ds_read_b128 v[236:239], v13 offset:16384
    ds_read_b64_tr_b16 v[52:53], v17 offset:24576
    ds_read_b64_tr_b16 v[54:55], v17 offset:25088
    ds_read_b64_tr_b16 v[56:57], v17 offset:32768
    ds_read_b64_tr_b16 v[58:59], v17 offset:33280
    ds_read_b64_tr_b16 v[60:61], v17 offset:40960
    ds_read_b64_tr_b16 v[62:63], v17 offset:41472
    v_lshlrev_b32 v2, 16, v48
    v_and_b32 v3, 0xffff0000, v48
    v_add_f32 v22, v22, v2
    v_fmac_f32 v23, v2, v2
    v_mfma_f32_32x32x16_bf16 v[80:95], v[40:43], v[232:235], v[80:95]
    s_add_u32 m0, s67, 90112
    s_nop 0
    buffer_load_dwordx4 v9, s[16:19], s73 offen lds
    v_add_f32 v24, v24, v3
    v_fmac_f32 v25, v3, v3
    v_lshlrev_b32 v4, 16, v49
    v_and_b32 v5, 0xffff0000, v49
    v_mfma_f32_32x32x16_bf16 v[96:111], v[44:47], v[232:235], v[96:111]
    v_add_f32 v22, v22, v4
    v_fmac_f32 v23, v4, v4
    v_add_f32 v24, v24, v5
    v_fmac_f32 v25, v5, v5
    v_mfma_f32_16x16x32_bf16 v[252:255], v[240:243], v[44:47], v[252:255]
    s_waitcnt lgkmcnt(0)
    v_mfma_f32_32x32x16_bf16 v[64:79], v[52:55], v[236:239], v[64:79]
    s_waitcnt vmcnt(5)
    s_barrier
    s_cmp_lg_u32 s76, 0
    s_cbranch_scc1 K1_F0
    s_mov_b64 exec, 1
    buffer_store_dword v240, off, s[28:31], s75 sc1
    s_mov_b64 exec, -1
K1_F0:
    ds_read_b128 v[32:35], v10 offset:32768
    ds_read_b64_tr_b16 v[36:37], v18 offset:0
    ds_read_b64_tr_b16 v[38:39], v18 offset:512
    ds_read_b64_tr_b16 v[40:41], v18 offset:8192
    ds_read_b64_tr_b16 v[42:43], v18 offset:8704
    ds_read_b64_tr_b16 v[44:45], v18 offset:16384
    ds_read_b64_tr_b16 v[46:47], v18 offset:16896
    v_lshlrev_b32 v2, 16, v50
    v_and_b32 v3, 0xffff0000, v50
    v_add_f32 v22, v22, v2
    v_fmac_f32 v23, v2, v2
    v_mfma_f32_32x32x16_bf16 v[80:95], v[56:59], v[236:239], v[80:95]
    s_add_u32 s74, s83, 4
    s_and_b32 s74, s74, 7
    s_lshl_b32 s71, s74, 7
    s_mul_i32 s72, s74, s61
    s_mul_i32 s73, s74, s62
    s_add_u32 m0, s66, 0
    s_nop 0
    buffer_load_dwordx4 v6, s[4:7], s71 offen offset:0 lds
    v_add_f32 v24, v24, v3
    v_fmac_f32 v25, v3, v3
    v_lshlrev_b32 v4, 16, v51
    v_and_b32 v5, 0xffff0000, v51
    v_mfma_f32_16x16x32_bf16 v[248:251], v[240:243], v[56:59], v[248:251]
    v_mfma_f32_32x32x16_bf16 v[96:111], v[60:63], v[236:239], v[96:111]
    s_add_u32 m0, s66, 0
    s_nop 0
    buffer_load_dwordx4 v7, s[4:7], s71 offen offset:1024 lds
    v_add_f32 v22, v22, v4
    v_fmac_f32 v23, v4, v4
    v_add_f32 v24, v24, v5
    v_fmac_f32 v25, v5, v5
    s_waitcnt lgkmcnt(0)
    v_mfma_f32_32x32x16_bf16 v[64:79], v[36:39], v[32:35], v[64:79]
    ds_read_b128 v[48:51], v11 offset:32768
    ds_read_b64_tr_b16 v[52:53], v19 offset:0
    ds_read_b64_tr_b16 v[54:55], v19 offset:512
    ds_read_b64_tr_b16 v[56:57], v19 offset:8192
    ds_read_b64_tr_b16 v[58:59], v19 offset:8704
    ds_read_b64_tr_b16 v[60:61], v19 offset:16384
    ds_read_b64_tr_b16 v[62:63], v19 offset:16896
    v_lshlrev_b32 v2, 16, v32
    v_and_b32 v3, 0xffff0000, v32
    v_add_f32 v22, v22, v2
    v_fmac_f32 v23, v2, v2
    v_mfma_f32_32x32x16_bf16 v[80:95], v[40:43], v[32:35], v[80:95]
    s_add_u32 m0, s67, 0
    s_nop 0
    buffer_load_dwordx4 v8, s[8:11], s72 offen lds
    v_add_f32 v24, v24, v3
    v_fmac_f32 v25, v3, v3
    v_lshlrev_b32 v4, 16, v33
    v_and_b32 v5, 0xffff0000, v33
    v_mfma_f32_32x32x16_bf16 v[96:111], v[44:47], v[32:35], v[96:111]
    v_add_f32 v22, v22, v4
    v_fmac_f32 v23, v4, v4
    v_add_f32 v24, v24, v5
    v_fmac_f32 v25, v5, v5
    s_waitcnt lgkmcnt(0)
    v_mfma_f32_32x32x16_bf16 v[64:79], v[52:55], v[48:51], v[64:79]
    ds_read_b128 v[232:235], v12 offset:32768
    ds_read_b64_tr_b16 v[36:37], v20 offset:0
    ds_read_b64_tr_b16 v[38:39], v20 offset:512
    ds_read_b64_tr_b16 v[40:41], v20 offset:8192
    ds_read_b64_tr_b16 v[42:43], v20 offset:8704
    ds_read_b64_tr_b16 v[44:45], v20 offset:16384
    ds_read_b64_tr_b16 v[46:47], v20 offset:16896
    v_lshlrev_b32 v2, 16, v34
    v_and_b32 v3, 0xffff0000, v34
    v_add_f32 v22, v22, v2
    v_fmac_f32 v23, v2, v2
    v_mfma_f32_16x16x32_bf16 v[244:247], v[240:243], v[52:55], v[244:247]
    v_mfma_f32_32x32x16_bf16 v[80:95], v[56:59], v[48:51], v[80:95]
    s_add_u32 m0, s67, 8192
    s_nop 0
    buffer_load_dwordx4 v9, s[12:15], s73 offen lds
    v_add_f32 v24, v24, v3
    v_fmac_f32 v25, v3, v3
    v_lshlrev_b32 v4, 16, v35
    v_and_b32 v5, 0xffff0000, v35
    v_mfma_f32_32x32x16_bf16 v[96:111], v[60:63], v[48:51], v[96:111]
    v_add_f32 v22, v22, v4
    v_fmac_f32 v23, v4, v4
    v_add_f32 v24, v24, v5
    v_fmac_f32 v25, v5, v5
    s_waitcnt lgkmcnt(0)
    v_mfma_f32_32x32x16_bf16 v[64:79], v[36:39], v[232:235], v[64:79]
    ds_read_b128 v[236:239], v13 offset:32768
    ds_read_b64_tr_b16 v[52:53], v21 offset:0
    ds_read_b64_tr_b16 v[54:55], v21 offset:512
    ds_read_b64_tr_b16 v[56:57], v21 offset:8192
    ds_read_b64_tr_b16 v[58:59], v21 offset:8704
    ds_read_b64_tr_b16 v[60:61], v21 offset:16384
    ds_read_b64_tr_b16 v[62:63], v21 offset:16896
    v_lshlrev_b32 v2, 16, v48
    v_and_b32 v3, 0xffff0000, v48
    v_add_f32 v22, v22, v2
    v_fmac_f32 v23, v2, v2
    v_mfma_f32_32x32x16_bf16 v[80:95], v[40:43], v[232:235], v[80:95]
    s_add_u32 m0, s67, 16384
    s_nop 0
    buffer_load_dwordx4 v9, s[16:19], s73 offen lds
    v_add_f32 v24, v24, v3
    v_fmac_f32 v25, v3, v3
    v_lshlrev_b32 v4, 16, v49
    v_and_b32 v5, 0xffff0000, v49
    v_mfma_f32_32x32x16_bf16 v[96:111], v[44:47], v[232:235], v[96:111]
    v_add_f32 v22, v22, v4
    v_fmac_f32 v23, v4, v4
    v_add_f32 v24, v24, v5
    v_fmac_f32 v25, v5, v5
    v_mfma_f32_16x16x32_bf16 v[252:255], v[240:243], v[44:47], v[252:255]
    s_waitcnt lgkmcnt(0)
    v_mfma_f32_32x32x16_bf16 v[64:79], v[52:55], v[236:239], v[64:79]
    s_waitcnt vmcnt(5)
    s_barrier
    ds_read_b128 v[32:35], v10 offset:49152
    ds_read_b64_tr_b16 v[36:37], v18 offset:24576
    ds_read_b64_tr_b16 v[38:39], v18 offset:25088
    ds_read_b64_tr_b16 v[40:41], v18 offset:32768
    ds_read_b64_tr_b16 v[42:43], v18 offset:33280
    ds_read_b64_tr_b16 v[44:45], v18 offset:40960
    ds_read_b64_tr_b16 v[46:47], v18 offset:41472
    v_lshlrev_b32 v2, 16, v50
    v_and_b32 v3, 0xffff0000, v50
    v_add_f32 v22, v22, v2
    v_fmac_f32 v23, v2, v2
    v_mfma_f32_32x32x16_bf16 v[80:95], v[56:59], v[236:239], v[80:95]
    s_add_u32 s74, s83, 5
    s_and_b32 s74, s74, 7
    s_lshl_b32 s71, s74, 7
    s_mul_i32 s72, s74, s61
    s_mul_i32 s73, s74, s62
    s_add_u32 m0, s66, 16384
    s_nop 0
    buffer_load_dwordx4 v6, s[4:7], s71 offen offset:0 lds
    v_add_f32 v24, v24, v3
    v_fmac_f32 v25, v3, v3
    v_lshlrev_b32 v4, 16, v51
    v_and_b32 v5, 0xffff0000, v51
    v_mfma_f32_16x16x32_bf16 v[248:251], v[240:243], v[56:59], v[248:251]
    v_mfma_f32_32x32x16_bf16 v[96:111], v[60:63], v[236:239], v[96:111]
    s_add_u32 m0, s66, 16384
    s_nop 0
    buffer_load_dwordx4 v7, s[4:7], s71 offen offset:1024 lds
    v_add_f32 v22, v22, v4
    v_fmac_f32 v23, v4, v4
    v_add_f32 v24, v24, v5
    v_fmac_f32 v25, v5, v5
    s_waitcnt lgkmcnt(0)
    v_mfma_f32_32x32x16_bf16 v[64:79], v[36:39], v[32:35], v[64:79]
    ds_read_b128 v[48:51], v11 offset:49152
    ds_read_b64_tr_b16 v[52:53], v19 offset:24576
    ds_read_b64_tr_b16 v[54:55], v19 offset:25088
    ds_read_b64_tr_b16 v[56:57], v19 offset:32768
    ds_read_b64_tr_b16 v[58:59], v19 offset:33280
    ds_read_b64_tr_b16 v[60:61], v19 offset:40960
    ds_read_b64_tr_b16 v[62:63], v19 offset:41472
    v_lshlrev_b32 v2, 16, v32
    v_and_b32 v3, 0xffff0000, v32
    v_add_f32 v22, v22, v2
    v_fmac_f32 v23, v2, v2
    v_mfma_f32_32x32x16_bf16 v[80:95], v[40:43], v[32:35], v[80:95]
    s_add_u32 m0, s67, 24576
    s_nop 0
    buffer_load_dwordx4 v8, s[8:11], s72 offen lds
    v_add_f32 v24, v24, v3
    v_fmac_f32 v25, v3, v3
    v_lshlrev_b32 v4, 16, v33
    v_and_b32 v5, 0xffff0000, v33
    v_mfma_f32_32x32x16_bf16 v[96:111], v[44:47], v[32:35], v[96:111]
    v_add_f32 v22, v22, v4
    v_fmac_f32 v23, v4, v4
    v_add_f32 v24, v24, v5
    v_fmac_f32 v25, v5, v5
    s_waitcnt lgkmcnt(0)
    v_mfma_f32_32x32x16_bf16 v[64:79], v[52:55], v[48:51], v[64:79]
    ds_read_b128 v[232:235], v12 offset:49152
    ds_read_b64_tr_b16 v[36:37], v20 offset:24576
    ds_read_b64_tr_b16 v[38:39], v20 offset:25088
    ds_read_b64_tr_b16 v[40:41], v20 offset:32768
    ds_read_b64_tr_b16 v[42:43], v20 offset:33280
    ds_read_b64_tr_b16 v[44:45], v20 offset:40960
    ds_read_b64_tr_b16 v[46:47], v20 offset:41472
    v_lshlrev_b32 v2, 16, v34
    v_and_b32 v3, 0xffff0000, v34
    v_add_f32 v22, v22, v2
    v_fmac_f32 v23, v2, v2
    v_mfma_f32_16x16x32_bf16 v[244:247], v[240:243], v[52:55], v[244:247]
    v_mfma_f32_32x32x16_bf16 v[80:95], v[56:59], v[48:51], v[80:95]
    s_add_u32 m0, s67, 32768
    s_nop 0
    buffer_load_dwordx4 v9, s[12:15], s73 offen lds
    v_add_f32 v24, v24, v3
    v_fmac_f32 v25, v3, v3
    v_lshlrev_b32 v4, 16, v35
    v_and_b32 v5, 0xffff0000, v35
    v_mfma_f32_32x32x16_bf16 v[96:111], v[60:63], v[48:51], v[96:111]
    v_add_f32 v22, v22, v4
    v_fmac_f32 v23, v4, v4
    v_add_f32 v24, v24, v5
    v_fmac_f32 v25, v5, v5
    s_waitcnt lgkmcnt(0)
    v_mfma_f32_32x32x16_bf16 v[64:79], v[36:39], v[232:235], v[64:79]
    ds_read_b128 v[236:239], v13 offset:49152
    ds_read_b64_tr_b16 v[52:53], v21 offset:24576
    ds_read_b64_tr_b16 v[54:55], v21 offset:25088
    ds_read_b64_tr_b16 v[56:57], v21 offset:32768
    ds_read_b64_tr_b16 v[58:59], v21 offset:33280
    ds_read_b64_tr_b16 v[60:61], v21 offset:40960
    ds_read_b64_tr_b16 v[62:63], v21 offset:41472
    v_lshlrev_b32 v2, 16, v48
    v_and_b32 v3, 0xffff0000, v48
    v_add_f32 v22, v22, v2
    v_fmac_f32 v23, v2, v2
    v_mfma_f32_32x32x16_bf16 v[80:95], v[40:43], v[232:235], v[80:95]
    s_add_u32 m0, s67, 40960
    s_nop 0
    buffer_load_dwordx4 v9, s[16:19], s73 offen lds
    v_add_f32 v24, v24, v3
    v_fmac_f32 v25, v3, v3
    v_lshlrev_b32 v4, 16, v49
    v_and_b32 v5, 0xffff0000, v49
    v_mfma_f32_32x32x16_bf16 v[96:111], v[44:47], v[232:235], v[96:111]
    v_add_f32 v22, v22, v4
    v_fmac_f32 v23, v4, v4
    v_add_f32 v24, v24, v5
    v_fmac_f32 v25, v5, v5
    v_mfma_f32_16x16x32_bf16 v[252:255], v[240:243], v[44:47], v[252:255]
    s_waitcnt lgkmcnt(0)
    v_mfma_f32_32x32x16_bf16 v[64:79], v[52:55], v[236:239], v[64:79]
    s_waitcnt vmcnt(5)
    s_barrier
    ds_read_b128 v[32:35], v10 offset:0
    ds_read_b64_tr_b16 v[36:37], v14 offset:0
    ds_read_b64_tr_b16 v[38:39], v14 offset:512
    ds_read_b64_tr_b16 v[40:41], v14 offset:8192
    ds_read_b64_tr_b16 v[42:43], v14 offset:8704
    ds_read_b64_tr_b16 v[44:45], v14 offset:16384
    ds_read_b64_tr_b16 v[46:47], v14 offset:16896
    v_lshlrev_b32 v2, 16, v50
    v_and_b32 v3, 0xffff0000, v50
    v_add_f32 v22, v22, v2
    v_fmac_f32 v23, v2, v2
    v_mfma_f32_32x32x16_bf16 v[80:95], v[56:59], v[236:239], v[80:95]
    s_add_u32 s74, s83, 6
    s_and_b32 s74, s74, 7
    s_lshl_b32 s71, s74, 7
    s_mul_i32 s72, s74, s61
    s_mul_i32 s73, s74, s62
    s_add_u32 m0, s66, 32768
    s_nop 0
    buffer_load_dwordx4 v6, s[4:7], s71 offen offset:0 lds
    v_add_f32 v24, v24, v3
    v_fmac_f32 v25, v3, v3
    v_lshlrev_b32 v4, 16, v51
    v_and_b32 v5, 0xffff0000, v51
    v_mfma_f32_16x16x32_bf16 v[248:251], v[240:243], v[56:59], v[248:251]
    v_mfma_f32_32x32x16_bf16 v[96:111], v[60:63], v[236:239], v[96:111]
    s_add_u32 m0, s66, 32768
    s_nop 0
    buffer_load_dwordx4 v7, s[4:7], s71 offen offset:1024 lds
    v_add_f32 v22, v22, v4
    v_fmac_f32 v23, v4, v4
    v_add_f32 v24, v24, v5
    v_fmac_f32 v25, v5, v5
    s_lshr_b32 s64, s2, 3
    s_min_u32 s64, s64, 29
    s_sub_u32 s65, s64, 22
    s_cselect_b32 s24, s46, s38
    s_cselect_b32 s25, s47, s39
    s_mov_b32 s26, 524288
    s_cselect_b32 s26, 1409024, s26
    s_cselect_b32 s64, s64, s65
    s_lshl_b32 s64, s64, 16
    s_add_u32 s64, s64, 384
    buffer_load_dword v30, v26, s[24:27], s64 offen
    s_waitcnt lgkmcnt(0)
    v_mfma_f32_32x32x16_bf16 v[64:79], v[36:39], v[32:35], v[64:79]
    ds_read_b128 v[48:51], v11 offset:0
    ds_read_b64_tr_b16 v[52:53], v15 offset:0
    ds_read_b64_tr_b16 v[54:55], v15 offset:512
    ds_read_b64_tr_b16 v[56:57], v15 offset:8192
    ds_read_b64_tr_b16 v[58:59], v15 offset:8704
    ds_read_b64_tr_b16 v[60:61], v15 offset:16384
    ds_read_b64_tr_b16 v[62:63], v15 offset:16896
    v_lshlrev_b32 v2, 16, v32
    v_and_b32 v3, 0xffff0000, v32
    v_add_f32 v22, v22, v2
    v_fmac_f32 v23, v2, v2
    v_mfma_f32_32x32x16_bf16 v[80:95], v[40:43], v[32:35], v[80:95]
    s_add_u32 m0, s67, 49152
    s_nop 0
    buffer_load_dwordx4 v8, s[8:11], s72 offen lds
    v_add_f32 v24, v24, v3
    v_fmac_f32 v25, v3, v3
    v_lshlrev_b32 v4, 16, v33
    v_and_b32 v5, 0xffff0000, v33
    v_mfma_f32_32x32x16_bf16 v[96:111], v[44:47], v[32:35], v[96:111]
    v_add_f32 v22, v22, v4
    v_fmac_f32 v23, v4, v4
    v_add_f32 v24, v24, v5
    v_fmac_f32 v25, v5, v5
    s_waitcnt lgkmcnt(0)
    v_mfma_f32_32x32x16_bf16 v[64:79], v[52:55], v[48:51], v[64:79]
    ds_read_b128 v[232:235], v12 offset:0
    ds_read_b64_tr_b16 v[36:37], v16 offset:0
    ds_read_b64_tr_b16 v[38:39], v16 offset:512
    ds_read_b64_tr_b16 v[40:41], v16 offset:8192
    ds_read_b64_tr_b16 v[42:43], v16 offset:8704
    ds_read_b64_tr_b16 v[44:45], v16 offset:16384
    ds_read_b64_tr_b16 v[46:47], v16 offset:16896
    v_lshlrev_b32 v2, 16, v34
    v_and_b32 v3, 0xffff0000, v34
    v_add_f32 v22, v22, v2
    v_fmac_f32 v23, v2, v2
    v_mfma_f32_16x16x32_bf16 v[244:247], v[240:243], v[52:55], v[244:247]
    v_mfma_f32_32x32x16_bf16 v[80:95], v[56:59], v[48:51], v[80:95]
    s_add_u32 m0, s67, 57344
    s_nop 0
    buffer_load_dwordx4 v9, s[12:15], s73 offen lds
    v_add_f32 v24, v24, v3
    v_fmac_f32 v25, v3, v3
    v_lshlrev_b32 v4, 16, v35
    v_and_b32 v5, 0xffff0000, v35
    v_mfma_f32_32x32x16_bf16 v[96:111], v[60:63], v[48:51], v[96:111]
    v_add_f32 v22, v22, v4
    v_fmac_f32 v23, v4, v4
    v_add_f32 v24, v24, v5
    v_fmac_f32 v25, v5, v5
    s_waitcnt lgkmcnt(0)
    v_mfma_f32_32x32x16_bf16 v[64:79], v[36:39], v[232:235], v[64:79]
    ds_read_b128 v[236:239], v13 offset:0
    ds_read_b64_tr_b16 v[52:53], v17 offset:0
    ds_read_b64_tr_b16 v[54:55], v17 offset:512
    ds_read_b64_tr_b16 v[56:57], v17 offset:8192
    ds_read_b64_tr_b16 v[58:59], v17 offset:8704
    ds_read_b64_tr_b16 v[60:61], v17 offset:16384
    ds_read_b64_tr_b16 v[62:63], v17 offset:16896
    v_lshlrev_b32 v2, 16, v48
    v_and_b32 v3, 0xffff0000, v48
    v_add_f32 v22, v22, v2
    v_fmac_f32 v23, v2, v2
    v_mfma_f32_32x32x16_bf16 v[80:95], v[40:43], v[232:235], v[80:95]
    s_add_u32 m0, s67, 65536
    s_nop 0
    buffer_load_dwordx4 v9, s[16:19], s73 offen lds
    v_add_f32 v24, v24, v3
    v_fmac_f32 v25, v3, v3
    v_lshlrev_b32 v4, 16, v49
    v_and_b32 v5, 0xffff0000, v49
    v_mfma_f32_32x32x16_bf16 v[96:111], v[44:47], v[232:235], v[96:111]
    v_add_f32 v22, v22, v4
    v_fmac_f32 v23, v4, v4
    v_add_f32 v24, v24, v5
    v_fmac_f32 v25, v5, v5
    v_mfma_f32_16x16x32_bf16 v[252:255], v[240:243], v[44:47], v[252:255]
    s_waitcnt lgkmcnt(0)
    v_mfma_f32_32x32x16_bf16 v[64:79], v[52:55], v[236:239], v[64:79]
    s_waitcnt vmcnt(6)
    s_barrier
    ds_read_b128 v[32:35], v10 offset:16384
    ds_read_b64_tr_b16 v[36:37], v14 offset:24576
    ds_read_b64_tr_b16 v[38:39], v14 offset:25088
    ds_read_b64_tr_b16 v[40:41], v14 offset:32768
    ds_read_b64_tr_b16 v[42:43], v14 offset:33280
    ds_read_b64_tr_b16 v[44:45], v14 offset:40960
    ds_read_b64_tr_b16 v[46:47], v14 offset:41472
    v_lshlrev_b32 v2, 16, v50
    v_and_b32 v3, 0xffff0000, v50
    v_add_f32 v22, v22, v2
    v_fmac_f32 v23, v2, v2
    v_mfma_f32_32x32x16_bf16 v[80:95], v[56:59], v[236:239], v[80:95]
    s_add_u32 s74, s83, 7
    s_and_b32 s74, s74, 7
    s_lshl_b32 s71, s74, 7
    s_mul_i32 s72, s74, s61
    s_mul_i32 s73, s74, s62
    s_add_u32 m0, s66, 49152
    s_nop 0
    buffer_load_dwordx4 v6, s[4:7], s71 offen offset:0 lds
    v_add_f32 v24, v24, v3
    v_fmac_f32 v25, v3, v3
    v_lshlrev_b32 v4, 16, v51
    v_and_b32 v5, 0xffff0000, v51
    v_mfma_f32_16x16x32_bf16 v[248:251], v[240:243], v[56:59], v[248:251]
    v_mfma_f32_32x32x16_bf16 v[96:111], v[60:63], v[236:239], v[96:111]
    s_add_u32 m0, s66, 49152
    s_nop 0
    buffer_load_dwordx4 v7, s[4:7], s71 offen offset:1024 lds
    v_add_f32 v22, v22, v4
    v_fmac_f32 v23, v4, v4
    v_add_f32 v24, v24, v5
    v_fmac_f32 v25, v5, v5
    s_waitcnt lgkmcnt(0)
    v_mfma_f32_32x32x16_bf16 v[64:79], v[36:39], v[32:35], v[64:79]
    ds_read_b128 v[48:51], v11 offset:16384
    ds_read_b64_tr_b16 v[52:53], v15 offset:24576
    ds_read_b64_tr_b16 v[54:55], v15 offset:25088
    ds_read_b64_tr_b16 v[56:57], v15 offset:32768
    ds_read_b64_tr_b16 v[58:59], v15 offset:33280
    ds_read_b64_tr_b16 v[60:61], v15 offset:40960
    ds_read_b64_tr_b16 v[62:63], v15 offset:41472
    v_lshlrev_b32 v2, 16, v32
    v_and_b32 v3, 0xffff0000, v32
    v_add_f32 v22, v22, v2
    v_fmac_f32 v23, v2, v2
    v_mfma_f32_32x32x16_bf16 v[80:95], v[40:43], v[32:35], v[80:95]
    s_add_u32 m0, s67, 73728
    s_nop 0
    buffer_load_dwordx4 v8, s[8:11], s72 offen lds
    v_add_f32 v24, v24, v3
    v_fmac_f32 v25, v3, v3
    v_lshlrev_b32 v4, 16, v33
    v_and_b32 v5, 0xffff0000, v33
    v_mfma_f32_32x32x16_bf16 v[96:111], v[44:47], v[32:35], v[96:111]
    v_add_f32 v22, v22, v4
    v_fmac_f32 v23, v4, v4
    v_add_f32 v24, v24, v5
    v_fmac_f32 v25, v5, v5
    s_waitcnt lgkmcnt(0)
    v_mfma_f32_32x32x16_bf16 v[64:79], v[52:55], v[48:51], v[64:79]
    ds_read_b128 v[232:235], v12 offset:16384
    ds_read_b64_tr_b16 v[36:37], v16 offset:24576
    ds_read_b64_tr_b16 v[38:39], v16 offset:25088
    ds_read_b64_tr_b16 v[40:41], v16 offset:32768
    ds_read_b64_tr_b16 v[42:43], v16 offset:33280
    ds_read_b64_tr_b16 v[44:45], v16 offset:40960
    ds_read_b64_tr_b16 v[46:47], v16 offset:41472
    v_lshlrev_b32 v2, 16, v34
    v_and_b32 v3, 0xffff0000, v34
    v_add_f32 v22, v22, v2
    v_fmac_f32 v23, v2, v2
    v_mfma_f32_16x16x32_bf16 v[244:247], v[240:243], v[52:55], v[244:247]
    v_mfma_f32_32x32x16_bf16 v[80:95], v[56:59], v[48:51], v[80:95]
    s_add_u32 m0, s67, 81920
    s_nop 0
    buffer_load_dwordx4 v9, s[12:15], s73 offen lds
    v_add_f32 v24, v24, v3
    v_fmac_f32 v25, v3, v3
    v_lshlrev_b32 v4, 16, v35
    v_and_b32 v5, 0xffff0000, v35
    v_mfma_f32_32x32x16_bf16 v[96:111], v[60:63], v[48:51], v[96:111]
    v_add_f32 v22, v22, v4
    v_fmac_f32 v23, v4, v4
    v_add_f32 v24, v24, v5
    v_fmac_f32 v25, v5, v5
    s_waitcnt lgkmcnt(0)
    v_mfma_f32_32x32x16_bf16 v[64:79], v[36:39], v[232:235], v[64:79]
    ds_read_b128 v[236:239], v13 offset:16384
    ds_read_b64_tr_b16 v[52:53], v17 offset:24576
    ds_read_b64_tr_b16 v[54:55], v17 offset:25088
    ds_read_b64_tr_b16 v[56:57], v17 offset:32768
    ds_read_b64_tr_b16 v[58:59], v17 offset:33280
    ds_read_b64_tr_b16 v[60:61], v17 offset:40960
    ds_read_b64_tr_b16 v[62:63], v17 offset:41472
    v_lshlrev_b32 v2, 16, v48
    v_and_b32 v3, 0xffff0000, v48
    v_add_f32 v22, v22, v2
    v_fmac_f32 v23, v2, v2
    v_mfma_f32_32x32x16_bf16 v[80:95], v[40:43], v[232:235], v[80:95]
    s_add_u32 m0, s67, 90112
    s_nop 0
    buffer_load_dwordx4 v9, s[16:19], s73 offen lds
    v_add_f32 v24, v24, v3
    v_fmac_f32 v25, v3, v3
    v_lshlrev_b32 v4, 16, v49
    v_and_b32 v5, 0xffff0000, v49
    v_mfma_f32_32x32x16_bf16 v[96:111], v[44:47], v[232:235], v[96:111]
    v_add_f32 v22, v22, v4
    v_fmac_f32 v23, v4, v4
    v_add_f32 v24, v24, v5
    v_fmac_f32 v25, v5, v5
    v_mfma_f32_16x16x32_bf16 v[252:255], v[240:243], v[44:47], v[252:255]
    s_waitcnt lgkmcnt(0)
    v_mfma_f32_32x32x16_bf16 v[64:79], v[52:55], v[236:239], v[64:79]
    s_waitcnt vmcnt(5)
    s_barrier
    ds_read_b128 v[32:35], v10 offset:32768
    ds_read_b64_tr_b16 v[36:37], v18 offset:0
    ds_read_b64_tr_b16 v[38:39], v18 offset:512
    ds_read_b64_tr_b16 v[40:41], v18 offset:8192
    ds_read_b64_tr_b16 v[42:43], v18 offset:8704
    ds_read_b64_tr_b16 v[44:45], v18 offset:16384
    ds_read_b64_tr_b16 v[46:47], v18 offset:16896
    v_lshlrev_b32 v2, 16, v50
    v_and_b32 v3, 0xffff0000, v50
    v_add_f32 v22, v22, v2
    v_fmac_f32 v23, v2, v2
    v_mfma_f32_32x32x16_bf16 v[80:95], v[56:59], v[236:239], v[80:95]
    v_add_f32 v24, v24, v3
    v_fmac_f32 v25, v3, v3
    v_lshlrev_b32 v4, 16, v51
    v_and_b32 v5, 0xffff0000, v51
    v_mfma_f32_16x16x32_bf16 v[248:251], v[240:243], v[56:59], v[248:251]
    v_mfma_f32_32x32x16_bf16 v[96:111], v[60:63], v[236:239], v[96:111]
    v_add_f32 v22, v22, v4
    v_fmac_f32 v23, v4, v4
    v_add_f32 v24, v24, v5
    v_fmac_f32 v25, v5, v5
    s_waitcnt lgkmcnt(0)
    v_mfma_f32_32x32x16_bf16 v[64:79], v[36:39], v[32:35], v[64:79]
    ds_read_b128 v[48:51], v11 offset:32768
    ds_read_b64_tr_b16 v[52:53], v19 offset:0
    ds_read_b64_tr_b16 v[54:55], v19 offset:512
    ds_read_b64_tr_b16 v[56:57], v19 offset:8192
    ds_read_b64_tr_b16 v[58:59], v19 offset:8704
    ds_read_b64_tr_b16 v[60:61], v19 offset:16384
    ds_read_b64_tr_b16 v[62:63], v19 offset:16896
    v_lshlrev_b32 v2, 16, v32
    v_and_b32 v3, 0xffff0000, v32
    v_add_f32 v22, v22, v2
    v_fmac_f32 v23, v2, v2
    v_mfma_f32_32x32x16_bf16 v[80:95], v[40:43], v[32:35], v[80:95]
    v_add_f32 v24, v24, v3
    v_fmac_f32 v25, v3, v3
    v_lshlrev_b32 v4, 16, v33
    v_and_b32 v5, 0xffff0000, v33
    v_mfma_f32_32x32x16_bf16 v[96:111], v[44:47], v[32:35], v[96:111]
    v_add_f32 v22, v22, v4
    v_fmac_f32 v23, v4, v4
    v_add_f32 v24, v24, v5
    v_fmac_f32 v25, v5, v5
    s_waitcnt lgkmcnt(0)
    v_mfma_f32_32x32x16_bf16 v[64:79], v[52:55], v[48:51], v[64:79]
    ds_read_b128 v[232:235], v12 offset:32768
    ds_read_b64_tr_b16 v[36:37], v20 offset:0
    ds_read_b64_tr_b16 v[38:39], v20 offset:512
    ds_read_b64_tr_b16 v[40:41], v20 offset:8192
    ds_read_b64_tr_b16 v[42:43], v20 offset:8704
    ds_read_b64_tr_b16 v[44:45], v20 offset:16384
    ds_read_b64_tr_b16 v[46:47], v20 offset:16896
    v_lshlrev_b32 v2, 16, v34
    v_and_b32 v3, 0xffff0000, v34
    v_add_f32 v22, v22, v2
    v_fmac_f32 v23, v2, v2
    v_mfma_f32_16x16x32_bf16 v[244:247], v[240:243], v[52:55], v[244:247]
    v_mfma_f32_32x32x16_bf16 v[80:95], v[56:59], v[48:51], v[80:95]
    v_add_f32 v24, v24, v3
    v_fmac_f32 v25, v3, v3
    v_lshlrev_b32 v4, 16, v35
    v_and_b32 v5, 0xffff0000, v35
    v_mfma_f32_32x32x16_bf16 v[96:111], v[60:63], v[48:51], v[96:111]
    v_add_f32 v22, v22, v4
    v_fmac_f32 v23, v4, v4
    v_add_f32 v24, v24, v5
    v_fmac_f32 v25, v5, v5
    s_waitcnt lgkmcnt(0)
    v_mfma_f32_32x32x16_bf16 v[64:79], v[36:39], v[232:235], v[64:79]
    ds_read_b128 v[236:239], v13 offset:32768
    ds_read_b64_tr_b16 v[52:53], v21 offset:0
    ds_read_b64_tr_b16 v[54:55], v21 offset:512
    ds_read_b64_tr_b16 v[56:57], v21 offset:8192
    ds_read_b64_tr_b16 v[58:59], v21 offset:8704
    ds_read_b64_tr_b16 v[60:61], v21 offset:16384
    ds_read_b64_tr_b16 v[62:63], v21 offset:16896
    v_lshlrev_b32 v2, 16, v48
    v_and_b32 v3, 0xffff0000, v48
    v_add_f32 v22, v22, v2
    v_fmac_f32 v23, v2, v2
    v_mfma_f32_32x32x16_bf16 v[80:95], v[40:43], v[232:235], v[80:95]
    v_add_f32 v24, v24, v3
    v_fmac_f32 v25, v3, v3
    v_lshlrev_b32 v4, 16, v49
    v_and_b32 v5, 0xffff0000, v49
    v_mfma_f32_32x32x16_bf16 v[96:111], v[44:47], v[232:235], v[96:111]
    v_add_f32 v22, v22, v4
    v_fmac_f32 v23, v4, v4
    v_add_f32 v24, v24, v5
    v_fmac_f32 v25, v5, v5
    v_mfma_f32_16x16x32_bf16 v[252:255], v[240:243], v[44:47], v[252:255]
    s_waitcnt lgkmcnt(0)
    v_mfma_f32_32x32x16_bf16 v[64:79], v[52:55], v[236:239], v[64:79]
    s_waitcnt vmcnt(0)
    s_barrier
    ds_read_b128 v[32:35], v10 offset:49152
    ds_read_b64_tr_b16 v[36:37], v18 offset:24576
    ds_read_b64_tr_b16 v[38:39], v18 offset:25088
    ds_read_b64_tr_b16 v[40:41], v18 offset:32768
    ds_read_b64_tr_b16 v[42:43], v18 offset:33280
    ds_read_b64_tr_b16 v[44:45], v18 offset:40960
    ds_read_b64_tr_b16 v[46:47], v18 offset:41472
    v_lshlrev_b32 v2, 16, v50
    v_and_b32 v3, 0xffff0000, v50
    v_add_f32 v22, v22, v2
    v_fmac_f32 v23, v2, v2
    v_mfma_f32_32x32x16_bf16 v[80:95], v[56:59], v[236:239], v[80:95]
    v_add_f32 v24, v24, v3
    v_fmac_f32 v25, v3, v3
    v_lshlrev_b32 v4, 16, v51
    v_and_b32 v5, 0xffff0000, v51
    v_mfma_f32_16x16x32_bf16 v[248:251], v[240:243], v[56:59], v[248:251]
    v_mfma_f32_32x32x16_bf16 v[96:111], v[60:63], v[236:239], v[96:111]
    v_add_f32 v22, v22, v4
    v_fmac_f32 v23, v4, v4
    v_add_f32 v24, v24, v5
    v_fmac_f32 v25, v5, v5
    s_waitcnt lgkmcnt(0)
    v_mfma_f32_32x32x16_bf16 v[64:79], v[36:39], v[32:35], v[64:79]
    ds_read_b128 v[48:51], v11 offset:49152
    ds_read_b64_tr_b16 v[52:53], v19 offset:24576
    ds_read_b64_tr_b16 v[54:55], v19 offset:25088
    ds_read_b64_tr_b16 v[56:57], v19 offset:32768
    ds_read_b64_tr_b16 v[58:59], v19 offset:33280
    ds_read_b64_tr_b16 v[60:61], v19 offset:40960
    ds_read_b64_tr_b16 v[62:63], v19 offset:41472
    v_lshlrev_b32 v2, 16, v32
    v_and_b32 v3, 0xffff0000, v32
    v_add_f32 v22, v22, v2
    v_fmac_f32 v23, v2, v2
    v_mfma_f32_32x32x16_bf16 v[80:95], v[40:43], v[32:35], v[80:95]
    v_add_f32 v24, v24, v3
    v_fmac_f32 v25, v3, v3
    v_lshlrev_b32 v4, 16, v33
    v_and_b32 v5, 0xffff0000, v33
    v_mfma_f32_32x32x16_bf16 v[96:111], v[44:47], v[32:35], v[96:111]
    v_add_f32 v22, v22, v4
    v_fmac_f32 v23, v4, v4
    v_add_f32 v24, v24, v5
    v_fmac_f32 v25, v5, v5
    s_waitcnt lgkmcnt(0)
    v_mfma_f32_32x32x16_bf16 v[64:79], v[52:55], v[48:51], v[64:79]
    ds_read_b128 v[232:235], v12 offset:49152
    ds_read_b64_tr_b16 v[36:37], v20 offset:24576
    ds_read_b64_tr_b16 v[38:39], v20 offset:25088
    ds_read_b64_tr_b16 v[40:41], v20 offset:32768
    ds_read_b64_tr_b16 v[42:43], v20 offset:33280
    ds_read_b64_tr_b16 v[44:45], v20 offset:40960
    ds_read_b64_tr_b16 v[46:47], v20 offset:41472
    v_lshlrev_b32 v2, 16, v34
    v_and_b32 v3, 0xffff0000, v34
    v_add_f32 v22, v22, v2
    v_fmac_f32 v23, v2, v2
    v_mfma_f32_16x16x32_bf16 v[244:247], v[240:243], v[52:55], v[244:247]
    v_mfma_f32_32x32x16_bf16 v[80:95], v[56:59], v[48:51], v[80:95]
    v_add_f32 v24, v24, v3
    v_fmac_f32 v25, v3, v3
    v_lshlrev_b32 v4, 16, v35
    v_and_b32 v5, 0xffff0000, v35
    v_mfma_f32_32x32x16_bf16 v[96:111], v[60:63], v[48:51], v[96:111]
    v_add_f32 v22, v22, v4
    v_fmac_f32 v23, v4, v4
    v_add_f32 v24, v24, v5
    v_fmac_f32 v25, v5, v5
    s_waitcnt lgkmcnt(0)
    v_mfma_f32_32x32x16_bf16 v[64:79], v[36:39], v[232:235], v[64:79]
    ds_read_b128 v[236:239], v13 offset:49152
    ds_read_b64_tr_b16 v[52:53], v21 offset:24576
    ds_read_b64_tr_b16 v[54:55], v21 offset:25088
    ds_read_b64_tr_b16 v[56:57], v21 offset:32768
    ds_read_b64_tr_b16 v[58:59], v21 offset:33280
    ds_read_b64_tr_b16 v[60:61], v21 offset:40960
    ds_read_b64_tr_b16 v[62:63], v21 offset:41472
    v_lshlrev_b32 v2, 16, v48
    v_and_b32 v3, 0xffff0000, v48
    v_add_f32 v22, v22, v2
    v_fmac_f32 v23, v2, v2
    v_mfma_f32_32x32x16_bf16 v[80:95], v[40:43], v[232:235], v[80:95]
    v_add_f32 v24, v24, v3
    v_fmac_f32 v25, v3, v3
    v_lshlrev_b32 v4, 16, v49
    v_and_b32 v5, 0xffff0000, v49
    v_mfma_f32_32x32x16_bf16 v[96:111], v[44:47], v[232:235], v[96:111]
    v_add_f32 v22, v22, v4
    v_fmac_f32 v23, v4, v4
    v_add_f32 v24, v24, v5
    v_fmac_f32 v25, v5, v5
    v_mfma_f32_16x16x32_bf16 v[252:255], v[240:243], v[44:47], v[252:255]
    s_waitcnt lgkmcnt(0)
    v_mfma_f32_32x32x16_bf16 v[64:79], v[52:55], v[236:239], v[64:79]
    v_lshlrev_b32 v2, 16, v50
    v_and_b32 v3, 0xffff0000, v50
    v_add_f32 v22, v22, v2
    v_fmac_f32 v23, v2, v2
    v_mfma_f32_32x32x16_bf16 v[80:95], v[56:59], v[236:239], v[80:95]
    v_add_f32 v24, v24, v3
    v_fmac_f32 v25, v3, v3
    v_lshlrev_b32 v4, 16, v51
    v_and_b32 v5, 0xffff0000, v51
    v_mfma_f32_16x16x32_bf16 v[248:251], v[240:243], v[56:59], v[248:251]
    v_mfma_f32_32x32x16_bf16 v[96:111], v[60:63], v[236:239], v[96:111]
    v_add_f32 v22, v22, v4
    v_fmac_f32 v23, v4, v4
    v_add_f32 v24, v24, v5
    v_fmac_f32 v25, v5, v5
    v_lshlrev_b32 v30, 2, v1
    buffer_load_dword v30, v30, s[28:31], 0 offen sc1
    v_add_f32 v22, v22, v24
    v_add_f32 v23, v23, v25
    s_lshl_b32 s65, s59, 9
    s_lshl_b32 s64, s60, 8
    s_add_u32 s64, s64, s65
    v_lshlrev_b32 v3, 2, v1
    v_permlane32_swap_b32 v22, v23
    v_add_u32 v3, s64, v3
    s_mul_i32 s64, s60, 1536
    s_lshl_b32 s63, s59, 2
    s_add_u32 s63, s63, s64
    v_add_f32 v22, v22, v23
    v_lshl_add_u32 v5, v29, 4, s63
    ds_write_b32 v3, v22 offset:36864
    ds_write_b32 v5, v244 offset:38912
    ds_write_b32 v5, v252 offset:39936
    ds_write_b32 v5, v248 offset:39424
    s_waitcnt lgkmcnt(0)
    s_barrier
    s_add_u32 s65, s65, 36864
    v_lshl_add_u32 v3, v29, 2, s65
    v_lshl_add_u32 v4, v29, 4, s64
    ds_read2_b32 v[132:133], v3 offset0:0 offset1:64
    ds_read2_b32 v[134:135], v3 offset0:32 offset1:96
    ds_read_b128 v[136:139], v4 offset:38912
    ds_read_b128 v[140:143], v4 offset:39424
    ds_read_b128 v[144:147], v4 offset:39936
    s_add_u32 s8, s46, 0
    s_addc_u32 s9, s47, 0
    s_mov_b32 s10, 1409024
    s_mov_b32 s11, 0x00020000
    s_add_u32 s12, s38, 0
    s_addc_u32 s13, s39, 0
    s_mov_b32 s14, 524288
    s_mov_b32 s15, 0x00020000
    s_lshr_b32 s78, s57, 1
    s_xor_b32 s78, s78, 4
    s_lshl_b32 s78, s78, 7
    s_lshl_b32 s79, s58, 10
    s_add_u32 m0, s79, 43008
    s_add_u32 s74, s78, 0
    buffer_load_dwordx4 v26, s[12:15], s74 offen lds
    s_add_u32 m0, s79, 51200
    s_add_u32 s74, s78, 65536
    buffer_load_dwordx4 v26, s[12:15], s74 offen lds
    s_add_u32 m0, s79, 59392
    s_add_u32 s74, s78, 131072
    buffer_load_dwordx4 v26, s[12:15], s74 offen lds
    s_add_u32 m0, s79, 67584
    s_add_u32 s74, s78, 196608
    buffer_load_dwordx4 v26, s[12:15], s74 offen lds
    s_waitcnt lgkmcnt(0)
    v_add_f32 v132, v132, v133
    v_add_f32 v134, v134, v135
    v_mul_f32 v132, 0x3b000000, v132
    v_mul_f32 v134, 0x3b000000, v134
    v_fma_f32 v134, -v132, v132, v134
    v_max_f32 v134, 0, v134
    v_mov_b32 v3, 0x2edbe6ff
    v_fmac_f32 v3, 0x3f800054, v134
    v_rsq_f32 v31, v3
    v_cvt_pk_bf16_f32 v135, v132, v132
    v_and_b32 v135, 0xffff0000, v135
    v_sub_f32 v132, v132, v135
    v_mul_f32 v133, v3, v31
    v_cvt_pk_bf16_f32 v2, v133, v133
    v_and_b32 v2, 0xffff0000, v2
    v_sub_f32 v133, v133, v2
    v_cmp_gt_u32 vcc, 32, v1
    v_cvt_pk_bf16_f32 v148, v135, v132
    v_cvt_pk_bf16_f32 v149, v135, v2
    v_cvt_pk_bf16_f32 v150, v133, 0
    v_mov_b32 v151, 0
    v_cndmask_b32 v148, 0, v148, vcc
    v_cndmask_b32 v149, 0, v149, vcc
    v_cndmask_b32 v150, 0, v150, vcc
    v_add_f32 v136, v136, v137
    v_add_f32 v138, v138, v139
    v_add_f32 v136, v136, v138
    v_cvt_pk_bf16_f32 v152, -v136, -v136
    v_and_b32 v137, 0xffff0000, v152
    v_add_f32 v136, v136, v137
    v_cvt_pk_bf16_f32 v153, -v136, v112
    v_cvt_pk_bf16_f32 v154, v112, 0
    v_mov_b32 v155, 0
    v_add_f32 v140, v140, v141
    v_add_f32 v142, v142, v143
    v_add_f32 v140, v140, v142
    v_cvt_pk_bf16_f32 v156, -v140, -v140
    v_and_b32 v141, 0xffff0000, v156
    v_add_f32 v140, v140, v141
    v_cvt_pk_bf16_f32 v157, -v140, v113
    v_cvt_pk_bf16_f32 v158, v113, 0
    v_mov_b32 v159, 0
    v_add_f32 v144, v144, v145
    v_add_f32 v146, v146, v147
    v_add_f32 v144, v144, v146
    v_cvt_pk_bf16_f32 v160, -v144, -v144
    v_and_b32 v145, 0xffff0000, v160
    v_add_f32 v144, v144, v145
    v_cvt_pk_bf16_f32 v161, -v144, v114
    v_cvt_pk_bf16_f32 v162, v114, 0
    v_mov_b32 v163, 0
    s_add_u32 m0, s79, 75776
    s_add_u32 s74, s78, 262144
    buffer_load_dwordx4 v26, s[12:15], s74 offen lds
    s_add_u32 m0, s79, 83968
    s_add_u32 s74, s78, 327680
    buffer_load_dwordx4 v26, s[12:15], s74 offen lds
    v_mfma_f32_32x32x16_bf16 v[64:79], v[152:155], v[148:151], v[64:79]
    v_mfma_f32_32x32x16_bf16 v[80:95], v[156:159], v[148:151], v[80:95]
    v_mfma_f32_32x32x16_bf16 v[96:111], v[160:163], v[148:151], v[96:111]
    v_mov_b32 v48, 0xc0135761
    v_mov_b32 v50, 0xbdd2d3e8
    v_mov_b32 v52, 1.0
    v_mov_b32 v54, v31
    s_lshl_b32 s64, s56, 2
    s_add_u32 s64, s64, s59
    s_mul_i32 s64, s64, 86
    s_mul_i32 s65, s77, 6
    s_add_u32 s65, s65, s60
    s_lshl_b32 s63, s65, 1
    s_add_u32 s64, s64, s63
    s_lshl_b32 s64, s64, 10
    s_mul_i32 s81, s56, 10240
    s_add_u32 s81, s81, 10494976
    s_mul_i32 s82, s57, 10240
    s_add_u32 s82, s82, 10494976
    s_add_u32 m0, s79, 92160
    s_add_u32 s74, s78, 393216
    buffer_load_dwordx4 v26, s[12:15], s74 offen lds
    s_add_u32 m0, s79, 100352
    s_add_u32 s74, s78, 458752
    buffer_load_dwordx4 v26, s[12:15], s74 offen lds
    s_add_u32 m0, s79, 108544
    s_add_u32 s74, s78, 0
    buffer_load_dwordx4 v26, s[8:11], s74 offen lds
    s_add_u32 m0, s79, 116736
    s_add_u32 s74, s78, 65536
    buffer_load_dwordx4 v26, s[8:11], s74 offen lds
    s_cmp_ge_u32 s65, 43
    s_cbranch_scc1 MSK0
    v_pk_mul_f32 v[64:65], v[64:65], v[54:55] op_sel_hi:[1,0]
    v_pk_mul_f32 v[66:67], v[66:67], v[54:55] op_sel_hi:[1,0]
    v_pk_mul_f32 v[68:69], v[68:69], v[54:55] op_sel_hi:[1,0]
    v_pk_mul_f32 v[70:71], v[70:71], v[54:55] op_sel_hi:[1,0]
    v_pk_mul_f32 v[72:73], v[72:73], v[54:55] op_sel_hi:[1,0]
    v_pk_mul_f32 v[74:75], v[74:75], v[54:55] op_sel_hi:[1,0]
    v_pk_mul_f32 v[76:77], v[76:77], v[54:55] op_sel_hi:[1,0]
    v_pk_mul_f32 v[78:79], v[78:79], v[54:55] op_sel_hi:[1,0]
    v_pk_mul_f32 v[164:165], v[64:65], v[64:65]
    v_pk_mul_f32 v[166:167], v[66:67], v[66:67]
    v_pk_mul_f32 v[168:169], v[68:69], v[68:69]
    v_pk_mul_f32 v[170:171], v[70:71], v[70:71]
    v_pk_mul_f32 v[172:173], v[72:73], v[72:73]
    v_pk_mul_f32 v[174:175], v[74:75], v[74:75]
    v_pk_mul_f32 v[176:177], v[76:77], v[76:77]
    v_pk_mul_f32 v[178:179], v[78:79], v[78:79]
    v_pk_fma_f32 v[164:165], v[164:165], v[50:51], v[48:49] op_sel_hi:[1,0,0]
    v_pk_fma_f32 v[166:167], v[166:167], v[50:51], v[48:49] op_sel_hi:[1,0,0]
    v_pk_fma_f32 v[168:169], v[168:169], v[50:51], v[48:49] op_sel_hi:[1,0,0]
    v_pk_fma_f32 v[170:171], v[170:171], v[50:51], v[48:49] op_sel_hi:[1,0,0]
    v_pk_fma_f32 v[172:173], v[172:173], v[50:51], v[48:49] op_sel_hi:[1,0,0]
    v_pk_fma_f32 v[174:175], v[174:175], v[50:51], v[48:49] op_sel_hi:[1,0,0]
    v_pk_fma_f32 v[176:177], v[176:177], v[50:51], v[48:49] op_sel_hi:[1,0,0]
    v_pk_fma_f32 v[178:179], v[178:179], v[50:51], v[48:49] op_sel_hi:[1,0,0]
    s_add_u32 m0, s79, 124928
    s_add_u32 s74, s78, 131072
    buffer_load_dwordx4 v26, s[8:11], s74 offen lds
    s_add_u32 m0, s79, 133120
    s_add_u32 s74, s78, 196608
    buffer_load_dwordx4 v26, s[8:11], s74 offen lds
    v_pk_mul_f32 v[164:165], v[164:165], v[64:65]
    v_pk_mul_f32 v[166:167], v[166:167], v[66:67]
    v_pk_mul_f32 v[168:169], v[168:169], v[68:69]
    v_pk_mul_f32 v[170:171], v[170:171], v[70:71]
    v_pk_mul_f32 v[172:173], v[172:173], v[72:73]
    v_pk_mul_f32 v[174:175], v[174:175], v[74:75]
    v_pk_mul_f32 v[176:177], v[176:177], v[76:77]
    v_pk_mul_f32 v[178:179], v[178:179], v[78:79]
    v_exp_f32 v164, v164
    v_exp_f32 v165, v165
    v_exp_f32 v166, v166
    v_exp_f32 v167, v167
    v_exp_f32 v168, v168
    v_exp_f32 v169, v169
    v_exp_f32 v170, v170
    v_exp_f32 v171, v171
    v_exp_f32 v172, v172
    v_exp_f32 v173, v173
    v_exp_f32 v174, v174
    v_exp_f32 v175, v175
    v_exp_f32 v176, v176
    v_exp_f32 v177, v177
    v_exp_f32 v178, v178
    v_exp_f32 v179, v179
    s_add_u32 m0, s79, 141312
    s_add_u32 s74, s78, 262144
    buffer_load_dwordx4 v26, s[8:11], s74 offen lds
    s_add_u32 m0, s79, 149504
    s_add_u32 s74, s78, 327680
    buffer_load_dwordx4 v26, s[8:11], s74 offen lds
    v_pk_add_f32 v[164:165], v[164:165], v[52:53] op_sel_hi:[1,0]
    v_pk_add_f32 v[166:167], v[166:167], v[52:53] op_sel_hi:[1,0]
    v_pk_add_f32 v[168:169], v[168:169], v[52:53] op_sel_hi:[1,0]
    v_pk_add_f32 v[170:171], v[170:171], v[52:53] op_sel_hi:[1,0]
    v_pk_add_f32 v[172:173], v[172:173], v[52:53] op_sel_hi:[1,0]
    v_pk_add_f32 v[174:175], v[174:175], v[52:53] op_sel_hi:[1,0]
    v_pk_add_f32 v[176:177], v[176:177], v[52:53] op_sel_hi:[1,0]
    v_pk_add_f32 v[178:179], v[178:179], v[52:53] op_sel_hi:[1,0]
    v_rcp_f32 v164, v164
    v_rcp_f32 v165, v165
    v_rcp_f32 v166, v166
    v_rcp_f32 v167, v167
    v_rcp_f32 v168, v168
    v_rcp_f32 v169, v169
    v_rcp_f32 v170, v170
    v_rcp_f32 v171, v171
    v_rcp_f32 v172, v172
    v_rcp_f32 v173, v173
    v_rcp_f32 v174, v174
    v_rcp_f32 v175, v175
    v_rcp_f32 v176, v176
    v_rcp_f32 v177, v177
    v_rcp_f32 v178, v178
    v_rcp_f32 v179, v179
    s_add_u32 m0, s79, 0
    s_add_u32 s74, s78, 393216
    buffer_load_dwordx4 v26, s[8:11], s74 offen lds
    s_add_u32 m0, s79, 8192
    s_add_u32 s74, s78, 458752
    buffer_load_dwordx4 v26, s[8:11], s74 offen lds
    v_pk_mul_f32 v[64:65], v[64:65], v[164:165]
    v_pk_mul_f32 v[66:67], v[66:67], v[166:167]
    v_pk_mul_f32 v[68:69], v[68:69], v[168:169]
    v_pk_mul_f32 v[70:71], v[70:71], v[170:171]
    v_pk_mul_f32 v[72:73], v[72:73], v[172:173]
    v_pk_mul_f32 v[74:75], v[74:75], v[174:175]
    v_pk_mul_f32 v[76:77], v[76:77], v[176:177]
    v_pk_mul_f32 v[78:79], v[78:79], v[178:179]
    v_cvt_pk_bf16_f32 v64, v64, v65
    v_cvt_pk_bf16_f32 v65, v66, v67
    v_cvt_pk_bf16_f32 v66, v68, v69
    v_cvt_pk_bf16_f32 v67, v70, v71
    v_cvt_pk_bf16_f32 v68, v72, v73
    v_cvt_pk_bf16_f32 v69, v74, v75
    v_cvt_pk_bf16_f32 v70, v76, v77
    v_cvt_pk_bf16_f32 v71, v78, v79
    buffer_store_dwordx4 v[64:67], v27, s[20:23], s64 offen sc1
    buffer_store_dwordx4 v[68:71], v27, s[20:23], s64 offen offset:1024 sc1
    s_add_u32 s64, s64, 4096
    s_cmp_ge_u32 s65, 41
    s_cbranch_scc1 MSK1
    v_pk_mul_f32 v[80:81], v[80:81], v[54:55] op_sel_hi:[1,0]
    v_pk_mul_f32 v[82:83], v[82:83], v[54:55] op_sel_hi:[1,0]
    v_pk_mul_f32 v[84:85], v[84:85], v[54:55] op_sel_hi:[1,0]
    v_pk_mul_f32 v[86:87], v[86:87], v[54:55] op_sel_hi:[1,0]
    v_pk_mul_f32 v[88:89], v[88:89], v[54:55] op_sel_hi:[1,0]
    v_pk_mul_f32 v[90:91], v[90:91], v[54:55] op_sel_hi:[1,0]
    v_pk_mul_f32 v[92:93], v[92:93], v[54:55] op_sel_hi:[1,0]
    v_pk_mul_f32 v[94:95], v[94:95], v[54:55] op_sel_hi:[1,0]
    v_pk_mul_f32 v[164:165], v[80:81], v[80:81]
    v_pk_mul_f32 v[166:167], v[82:83], v[82:83]
    v_pk_mul_f32 v[168:169], v[84:85], v[84:85]
    v_pk_mul_f32 v[170:171], v[86:87], v[86:87]
    v_pk_mul_f32 v[172:173], v[88:89], v[88:89]
    v_pk_mul_f32 v[174:175], v[90:91], v[90:91]
    v_pk_mul_f32 v[176:177], v[92:93], v[92:93]
    v_pk_mul_f32 v[178:179], v[94:95], v[94:95]
    v_pk_fma_f32 v[164:165], v[164:165], v[50:51], v[48:49] op_sel_hi:[1,0,0]
    v_pk_fma_f32 v[166:167], v[166:167], v[50:51], v[48:49] op_sel_hi:[1,0,0]
    v_pk_fma_f32 v[168:169], v[168:169], v[50:51], v[48:49] op_sel_hi:[1,0,0]
    v_pk_fma_f32 v[170:171], v[170:171], v[50:51], v[48:49] op_sel_hi:[1,0,0]
    v_pk_fma_f32 v[172:173], v[172:173], v[50:51], v[48:49] op_sel_hi:[1,0,0]
    v_pk_fma_f32 v[174:175], v[174:175], v[50:51], v[48:49] op_sel_hi:[1,0,0]
    v_pk_fma_f32 v[176:177], v[176:177], v[50:51], v[48:49] op_sel_hi:[1,0,0]
    v_pk_fma_f32 v[178:179], v[178:179], v[50:51], v[48:49] op_sel_hi:[1,0,0]
    s_add_u32 m0, s79, 16384
    s_add_u32 s74, s78, 524288
    buffer_load_dwordx4 v26, s[8:11], s74 offen lds
    s_add_u32 m0, s79, 24576
    s_add_u32 s74, s78, 589824
    buffer_load_dwordx4 v26, s[8:11], s74 offen lds
    v_pk_mul_f32 v[164:165], v[164:165], v[80:81]
    v_pk_mul_f32 v[166:167], v[166:167], v[82:83]
    v_pk_mul_f32 v[168:169], v[168:169], v[84:85]
    v_pk_mul_f32 v[170:171], v[170:171], v[86:87]
    v_pk_mul_f32 v[172:173], v[172:173], v[88:89]
    v_pk_mul_f32 v[174:175], v[174:175], v[90:91]
    v_pk_mul_f32 v[176:177], v[176:177], v[92:93]
    v_pk_mul_f32 v[178:179], v[178:179], v[94:95]
    v_exp_f32 v164, v164
    v_exp_f32 v165, v165
    v_exp_f32 v166, v166
    v_exp_f32 v167, v167
    v_exp_f32 v168, v168
    v_exp_f32 v169, v169
    v_exp_f32 v170, v170
    v_exp_f32 v171, v171
    v_exp_f32 v172, v172
    v_exp_f32 v173, v173
    v_exp_f32 v174, v174
    v_exp_f32 v175, v175
    v_exp_f32 v176, v176
    v_exp_f32 v177, v177
    v_exp_f32 v178, v178
    v_exp_f32 v179, v179
    v_pk_add_f32 v[164:165], v[164:165], v[52:53] op_sel_hi:[1,0]
    v_pk_add_f32 v[166:167], v[166:167], v[52:53] op_sel_hi:[1,0]
    v_pk_add_f32 v[168:169], v[168:169], v[52:53] op_sel_hi:[1,0]
    v_pk_add_f32 v[170:171], v[170:171], v[52:53] op_sel_hi:[1,0]
    v_pk_add_f32 v[172:173], v[172:173], v[52:53] op_sel_hi:[1,0]
    v_pk_add_f32 v[174:175], v[174:175], v[52:53] op_sel_hi:[1,0]
    v_pk_add_f32 v[176:177], v[176:177], v[52:53] op_sel_hi:[1,0]
    v_pk_add_f32 v[178:179], v[178:179], v[52:53] op_sel_hi:[1,0]
    v_rcp_f32 v164, v164
    v_rcp_f32 v165, v165
    v_rcp_f32 v166, v166
    v_rcp_f32 v167, v167
    v_rcp_f32 v168, v168
    v_rcp_f32 v169, v169
    v_rcp_f32 v170, v170
    v_rcp_f32 v171, v171
    v_rcp_f32 v172, v172
    v_rcp_f32 v173, v173
    v_rcp_f32 v174, v174
    v_rcp_f32 v175, v175
    v_rcp_f32 v176, v176
    v_rcp_f32 v177, v177
    v_rcp_f32 v178, v178
    v_rcp_f32 v179, v179
    v_pk_mul_f32 v[80:81], v[80:81], v[164:165]
    v_pk_mul_f32 v[82:83], v[82:83], v[166:167]
    v_pk_mul_f32 v[84:85], v[84:85], v[168:169]
    v_pk_mul_f32 v[86:87], v[86:87], v[170:171]
    v_pk_mul_f32 v[88:89], v[88:89], v[172:173]
    v_pk_mul_f32 v[90:91], v[90:91], v[174:175]
    v_pk_mul_f32 v[92:93], v[92:93], v[176:177]
    v_pk_mul_f32 v[94:95], v[94:95], v[178:179]
    v_cvt_pk_bf16_f32 v80, v80, v81
    v_cvt_pk_bf16_f32 v81, v82, v83
    v_cvt_pk_bf16_f32 v82, v84, v85
    v_cvt_pk_bf16_f32 v83, v86, v87
    v_cvt_pk_bf16_f32 v84, v88, v89
    v_cvt_pk_bf16_f32 v85, v90, v91
    v_cvt_pk_bf16_f32 v86, v92, v93
    v_cvt_pk_bf16_f32 v87, v94, v95
    buffer_store_dwordx4 v[80:83], v27, s[20:23], s64 offen sc1
    buffer_store_dwordx4 v[84:87], v27, s[20:23], s64 offen offset:1024 sc1
    s_add_u32 s64, s64, 4096
    v_pk_mul_f32 v[96:97], v[96:97], v[54:55] op_sel_hi:[1,0]
    v_pk_mul_f32 v[98:99], v[98:99], v[54:55] op_sel_hi:[1,0]
    v_pk_mul_f32 v[100:101], v[100:101], v[54:55] op_sel_hi:[1,0]
    v_pk_mul_f32 v[102:103], v[102:103], v[54:55] op_sel_hi:[1,0]
    v_pk_mul_f32 v[104:105], v[104:105], v[54:55] op_sel_hi:[1,0]
    v_pk_mul_f32 v[106:107], v[106:107], v[54:55] op_sel_hi:[1,0]
    v_pk_mul_f32 v[108:109], v[108:109], v[54:55] op_sel_hi:[1,0]
    v_pk_mul_f32 v[110:111], v[110:111], v[54:55] op_sel_hi:[1,0]
    v_pk_mul_f32 v[164:165], v[96:97], v[96:97]
    v_pk_mul_f32 v[166:167], v[98:99], v[98:99]
    v_pk_mul_f32 v[168:169], v[100:101], v[100:101]
    v_pk_mul_f32 v[170:171], v[102:103], v[102:103]
    v_pk_mul_f32 v[172:173], v[104:105], v[104:105]
    v_pk_mul_f32 v[174:175], v[106:107], v[106:107]
    v_pk_mul_f32 v[176:177], v[108:109], v[108:109]
    v_pk_mul_f32 v[178:179], v[110:111], v[110:111]
    v_pk_fma_f32 v[164:165], v[164:165], v[50:51], v[48:49] op_sel_hi:[1,0,0]
    v_pk_fma_f32 v[166:167], v[166:167], v[50:51], v[48:49] op_sel_hi:[1,0,0]
    v_pk_fma_f32 v[168:169], v[168:169], v[50:51], v[48:49] op_sel_hi:[1,0,0]
    v_pk_fma_f32 v[170:171], v[170:171], v[50:51], v[48:49] op_sel_hi:[1,0,0]
    v_pk_fma_f32 v[172:173], v[172:173], v[50:51], v[48:49] op_sel_hi:[1,0,0]
    v_pk_fma_f32 v[174:175], v[174:175], v[50:51], v[48:49] op_sel_hi:[1,0,0]
    v_pk_fma_f32 v[176:177], v[176:177], v[50:51], v[48:49] op_sel_hi:[1,0,0]
    v_pk_fma_f32 v[178:179], v[178:179], v[50:51], v[48:49] op_sel_hi:[1,0,0]
    v_pk_mul_f32 v[164:165], v[164:165], v[96:97]
    v_pk_mul_f32 v[166:167], v[166:167], v[98:99]
    v_pk_mul_f32 v[168:169], v[168:169], v[100:101]
    v_pk_mul_f32 v[170:171], v[170:171], v[102:103]
    v_pk_mul_f32 v[172:173], v[172:173], v[104:105]
    v_pk_mul_f32 v[174:175], v[174:175], v[106:107]
    v_pk_mul_f32 v[176:177], v[176:177], v[108:109]
    v_pk_mul_f32 v[178:179], v[178:179], v[110:111]
    v_exp_f32 v164, v164
    v_exp_f32 v165, v165
    v_exp_f32 v166, v166
    v_exp_f32 v167, v167
    v_exp_f32 v168, v168
    v_exp_f32 v169, v169
    v_exp_f32 v170, v170
    v_exp_f32 v171, v171
    v_exp_f32 v172, v172
    v_exp_f32 v173, v173
    v_exp_f32 v174, v174
    v_exp_f32 v175, v175
    v_exp_f32 v176, v176
    v_exp_f32 v177, v177
    v_exp_f32 v178, v178
    v_exp_f32 v179, v179
    v_pk_add_f32 v[164:165], v[164:165], v[52:53] op_sel_hi:[1,0]
    v_pk_add_f32 v[166:167], v[166:167], v[52:53] op_sel_hi:[1,0]
    v_pk_add_f32 v[168:169], v[168:169], v[52:53] op_sel_hi:[1,0]
    v_pk_add_f32 v[170:171], v[170:171], v[52:53] op_sel_hi:[1,0]
    v_pk_add_f32 v[172:173], v[172:173], v[52:53] op_sel_hi:[1,0]
    v_pk_add_f32 v[174:175], v[174:175], v[52:53] op_sel_hi:[1,0]
    v_pk_add_f32 v[176:177], v[176:177], v[52:53] op_sel_hi:[1,0]
    v_pk_add_f32 v[178:179], v[178:179], v[52:53] op_sel_hi:[1,0]
    v_rcp_f32 v164, v164
    v_rcp_f32 v165, v165
    v_rcp_f32 v166, v166
    v_rcp_f32 v167, v167
    v_rcp_f32 v168, v168
    v_rcp_f32 v169, v169
    v_rcp_f32 v170, v170
    v_rcp_f32 v171, v171
    v_rcp_f32 v172, v172
    v_rcp_f32 v173, v173
    v_rcp_f32 v174, v174
    v_rcp_f32 v175, v175
    v_rcp_f32 v176, v176
    v_rcp_f32 v177, v177
    v_rcp_f32 v178, v178
    v_rcp_f32 v179, v179
    v_pk_mul_f32 v[96:97], v[96:97], v[164:165]
    v_pk_mul_f32 v[98:99], v[98:99], v[166:167]
    v_pk_mul_f32 v[100:101], v[100:101], v[168:169]
    v_pk_mul_f32 v[102:103], v[102:103], v[170:171]
    v_pk_mul_f32 v[104:105], v[104:105], v[172:173]
    v_pk_mul_f32 v[106:107], v[106:107], v[174:175]
    v_pk_mul_f32 v[108:109], v[108:109], v[176:177]
    v_pk_mul_f32 v[110:111], v[110:111], v[178:179]
    v_cvt_pk_bf16_f32 v96, v96, v97
    v_cvt_pk_bf16_f32 v97, v98, v99
    v_cvt_pk_bf16_f32 v98, v100, v101
    v_cvt_pk_bf16_f32 v99, v102, v103
    v_cvt_pk_bf16_f32 v100, v104, v105
    v_cvt_pk_bf16_f32 v101, v106, v107
    v_cvt_pk_bf16_f32 v102, v108, v109
    v_cvt_pk_bf16_f32 v103, v110, v111
    buffer_store_dwordx4 v[96:99], v27, s[20:23], s64 offen sc1
    buffer_store_dwordx4 v[100:103], v27, s[20:23], s64 offen offset:1024 sc1
    s_add_u32 s64, s64, 4096
    s_branch MDONE
MSK0:
    s_add_u32 m0, s79, 124928
    s_add_u32 s74, s78, 131072
    buffer_load_dwordx4 v26, s[8:11], s74 offen lds
    s_add_u32 m0, s79, 133120
    s_add_u32 s74, s78, 196608
    buffer_load_dwordx4 v26, s[8:11], s74 offen lds
    s_add_u32 m0, s79, 141312
    s_add_u32 s74, s78, 262144
    buffer_load_dwordx4 v26, s[8:11], s74 offen lds
    s_add_u32 m0, s79, 149504
    s_add_u32 s74, s78, 327680
    buffer_load_dwordx4 v26, s[8:11], s74 offen lds
    s_add_u32 m0, s79, 0
    s_add_u32 s74, s78, 393216
    buffer_load_dwordx4 v26, s[8:11], s74 offen lds
    s_add_u32 m0, s79, 8192
    s_add_u32 s74, s78, 458752
    buffer_load_dwordx4 v26, s[8:11], s74 offen lds
MSK1:
    s_add_u32 m0, s79, 16384
    s_add_u32 s74, s78, 524288
    buffer_load_dwordx4 v26, s[8:11], s74 offen lds
    s_add_u32 m0, s79, 24576
    s_add_u32 s74, s78, 589824
    buffer_load_dwordx4 v26, s[8:11], s74 offen lds
MDONE:
    s_waitcnt vmcnt(0)
    s_waitcnt vmcnt(26)
    s_cmp_lg_u32 s58, 0
    s_cbranch_scc1 MZCD
    s_mov_b32 s80, 400000
MZC:
    v_cmp_ne_u32 vcc, 0, v30
    s_and_b32 s65, vcc_lo, 0xffff
    s_cmp_eq_u32 s65, 0xffff
    s_cbranch_scc1 MZCD
    s_sub_u32 s80, s80, 1
    s_cbranch_scc1 MZCD
    v_lshlrev_b32 v30, 2, v1
    buffer_load_dword v30, v30, s[28:31], 0 offen sc1
    s_waitcnt vmcnt(0)
    s_branch MZC
MZCD:
    v_mov_b32 v30, 0
    s_waitcnt vmcnt(0)
    s_barrier
    s_cmp_lg_u32 s58, 0
    s_cbranch_scc1 MSH
    s_mov_b64 exec, 1
    v_mov_b32 v5, 1
    buffer_atomic_add v5, off, s[20:23], s81 offset:256
    s_mov_b64 exec, -1
MSH:
    s_add_u32 m0, s79, 32768
    s_add_u32 s74, s78, 655360
    buffer_load_dwordx4 v26, s[8:11], s74 offen lds
    s_lshr_b32 s66, s58, 1
    s_and_b32 s67, s58, 1
    s_and_b32 s64, s57, 1
    s_lshl_b32 s71, s64, 16
    s_lshl_b32 s64, s64, 1
    s_add_u32 s64, s64, s67
    s_lshl_b32 s65, s56, 2
    s_add_u32 s64, s64, s65
    s_mul_i32 s62, s64, 86
    s_add_u32 s62, s62, s66
    s_lshl_b32 s62, s62, 10
    s_lshl_b32 s63, s64, 5
    s_add_u32 s63, s63, s66
    s_lshl_b32 s63, s63, 10
    s_add_u32 s63, s63, 6291456
    s_lshl_b32 s72, s58, 13
    s_add_u32 s71, s71, s72
    s_add_u32 s71, s71, s78
    s_lshl_b32 s65, s56, 17
    v_lshrrev_b32 v4, 3, v1
    v_and_b32 v3, 7, v1
    v_lshlrev_b32 v3, 4, v3
    v_lshl_add_u32 v7, v4, 10, v3
    s_add_u32 s16, s50, s65
    s_addc_u32 s17, s51, 0
    s_mov_b32 s18, 131072
    s_mov_b32 s19, 0x00020000
    s_add_u32 s24, s48, 0
    s_addc_u32 s25, s49, 0
    s_mov_b32 s26, 1024
    s_mov_b32 s27, 0x00020000
    s_sub_u32 s64, s66, s69
    s_lshl_b32 s64, s64, 11
    s_sub_u32 s64, s64, 0x10000
    s_lshl_b32 s65, s60, 6
    v_add_u32 v2, s64, v14
    v_xor_b32 v10, s65, v2
    v_xor_b32 v11, 64, v10
    v_add_u32 v12, 0xf000, v10
    v_add_u32 v13, 0xf000, v11
    v_add_u32 v14, 0x1e000, v10
    v_add_u32 v15, 0x1e000, v11
    ds_read_b64_tr_b16 v[160:161], v10 offset:43008
    ds_read_b64_tr_b16 v[162:163], v10 offset:43520
    ds_read_b64_tr_b16 v[164:165], v11 offset:43008
    ds_read_b64_tr_b16 v[166:167], v11 offset:43520
    ds_read_b64_tr_b16 v[168:169], v10 offset:51200
    ds_read_b64_tr_b16 v[170:171], v10 offset:51712
    ds_read_b64_tr_b16 v[172:173], v11 offset:51200
    ds_read_b64_tr_b16 v[174:175], v11 offset:51712
    ds_read_b64_tr_b16 v[176:177], v10 offset:59392
    ds_read_b64_tr_b16 v[178:179], v10 offset:59904
    ds_read_b64_tr_b16 v[180:181], v11 offset:59392
    ds_read_b64_tr_b16 v[182:183], v11 offset:59904
    ds_read_b64_tr_b16 v[184:185], v12 offset:6144
    ds_read_b64_tr_b16 v[186:187], v12 offset:6656
    ds_read_b64_tr_b16 v[188:189], v13 offset:6144
    ds_read_b64_tr_b16 v[190:191], v13 offset:6656
    ds_read_b64_tr_b16 v[192:193], v12 offset:14336
    ds_read_b64_tr_b16 v[194:195], v12 offset:14848
    ds_read_b64_tr_b16 v[196:197], v13 offset:14336
    ds_read_b64_tr_b16 v[198:199], v13 offset:14848
    ds_read_b64_tr_b16 v[200:201], v12 offset:22528
    ds_read_b64_tr_b16 v[202:203], v12 offset:23040
    ds_read_b64_tr_b16 v[204:205], v13 offset:22528
    ds_read_b64_tr_b16 v[206:207], v13 offset:23040
    ds_read_b64_tr_b16 v[208:209], v12 offset:30720
    ds_read_b64_tr_b16 v[210:211], v12 offset:31232
    ds_read_b64_tr_b16 v[212:213], v13 offset:30720
    ds_read_b64_tr_b16 v[214:215], v13 offset:31232
    ds_read_b64_tr_b16 v[216:217], v12 offset:38912
    ds_read_b64_tr_b16 v[218:219], v12 offset:39424
    ds_read_b64_tr_b16 v[220:221], v13 offset:38912
    ds_read_b64_tr_b16 v[222:223], v13 offset:39424
    v_and_b32 v3, 0x70, v7
    buffer_load_dwordx4 v[104:107], v7, s[4:7], s71 offen
    buffer_load_dwordx4 v[108:111], v3, s[24:27], s78 offen
    s_waitcnt lgkmcnt(0)
    s_barrier
    s_add_u32 m0, s79, 43008
    s_add_u32 s74, s78, 720896
    buffer_load_dwordx4 v26, s[8:11], s74 offen lds
    s_add_u32 m0, s79, 51200
    s_add_u32 s74, s78, 786432
    buffer_load_dwordx4 v26, s[8:11], s74 offen lds
    s_add_u32 m0, s79, 59392
    s_add_u32 s74, s78, 851968
    buffer_load_dwordx4 v26, s[8:11], s74 offen lds
    s_add_u32 m0, s79, 67584
    s_add_u32 s74, s78, 917504
    buffer_load_dwordx4 v26, s[8:11], s74 offen lds
    s_add_u32 m0, s79, 75776
    s_add_u32 s74, s78, 983040
    buffer_load_dwordx4 v26, s[8:11], s74 offen lds
    s_add_u32 m0, s79, 83968
    s_add_u32 s74, s78, 1048576
    buffer_load_dwordx4 v26, s[8:11], s74 offen lds
    s_add_u32 m0, s79, 92160
    s_add_u32 s74, s78, 1114112
    buffer_load_dwordx4 v26, s[8:11], s74 offen lds
    s_add_u32 m0, s79, 100352
    s_add_u32 s74, s78, 1179648
    buffer_load_dwordx4 v26, s[8:11], s74 offen lds
    ds_read_b64_tr_b16 v[64:65], v12 offset:47104
    ds_read_b64_tr_b16 v[66:67], v12 offset:47616
    ds_read_b64_tr_b16 v[68:69], v13 offset:47104
    ds_read_b64_tr_b16 v[70:71], v13 offset:47616
    s_cmp_lg_u32 s58, 0
    s_cbranch_scc1 PMHD
    s_mov_b32 s80, 400000
PMH:
    v_readfirstlane_b32 s65, v30
    s_nop 0
    s_cmp_ge_u32 s65, 8
    s_cbranch_scc1 PMHD
    s_sub_u32 s80, s80, 1
    s_cbranch_scc1 PMHD
    buffer_load_dword v30, off, s[20:23], s81 offset:256 sc1
    s_waitcnt vmcnt(0)
    s_branch PMH
PMHD:
    s_barrier
    buffer_load_dwordx4 v[112:115], v27, s[20:23], s62 offen sc1
    s_add_u32 s62, s62, 4096
    buffer_load_dwordx4 v[116:119], v27, s[20:23], s62 offen sc1
    s_add_u32 s62, s62, 4096
    buffer_load_dwordx4 v[120:123], v27, s[20:23], s62 offen sc1
    s_add_u32 s62, s62, 4096
    buffer_load_dwordx4 v[124:127], v27, s[20:23], s62 offen sc1
    s_add_u32 s62, s62, 4096
    buffer_load_dwordx4 v[128:131], v27, s[20:23], s62 offen sc1
    s_add_u32 s62, s62, 4096
    buffer_load_dwordx4 v[132:135], v27, s[20:23], s62 offen sc1
    s_add_u32 s62, s62, 4096
    buffer_load_dwordx4 v[136:139], v27, s[20:23], s62 offen sc1
    s_add_u32 s62, s62, 4096
    buffer_load_dwordx4 v[140:143], v27, s[20:23], s62 offen sc1
    s_add_u32 s62, s62, 4096
    ds_read_b64_tr_b16 v[72:73], v12 offset:55296
    ds_read_b64_tr_b16 v[74:75], v12 offset:55808
    ds_read_b64_tr_b16 v[76:77], v13 offset:55296
    ds_read_b64_tr_b16 v[78:79], v13 offset:55808
    s_waitcnt lgkmcnt(4)
    s_waitcnt vmcnt(7)
    v_mfma_f32_32x32x16_bf16 v[32:47], v[64:67], v[112:115], 0
    v_mfma_f32_32x32x16_bf16 v[48:63], v[68:71], v[112:115], 0
    buffer_load_dwordx4 v[112:115], v27, s[20:23], s62 offen sc1
    s_add_u32 s62, s62, 4096
    ds_read_b64_tr_b16 v[64:65], v14 offset:2048
    ds_read_b64_tr_b16 v[66:67], v14 offset:2560
    ds_read_b64_tr_b16 v[68:69], v15 offset:2048
    ds_read_b64_tr_b16 v[70:71], v15 offset:2560
    s_waitcnt lgkmcnt(4)
    s_waitcnt vmcnt(7)
    v_mfma_f32_32x32x16_bf16 v[32:47], v[72:75], v[116:119], v[32:47]
    v_mfma_f32_32x32x16_bf16 v[48:63], v[76:79], v[116:119], v[48:63]
    buffer_load_dwordx4 v[116:119], v27, s[20:23], s62 offen sc1
    s_add_u32 s62, s62, 4096
    ds_read_b64_tr_b16 v[72:73], v14 offset:10240
    ds_read_b64_tr_b16 v[74:75], v14 offset:10752
    ds_read_b64_tr_b16 v[76:77], v15 offset:10240
    ds_read_b64_tr_b16 v[78:79], v15 offset:10752
    s_waitcnt lgkmcnt(4)
    s_waitcnt vmcnt(7)
    v_mfma_f32_32x32x16_bf16 v[32:47], v[64:67], v[120:123], v[32:47]
    v_mfma_f32_32x32x16_bf16 v[48:63], v[68:71], v[120:123], v[48:63]
    buffer_load_dwordx4 v[120:123], v27, s[20:23], s62 offen sc1
    s_add_u32 s62, s62, 4096
    ds_read_b64_tr_b16 v[64:65], v14 offset:18432
    ds_read_b64_tr_b16 v[66:67], v14 offset:18944
    ds_read_b64_tr_b16 v[68:69], v15 offset:18432
    ds_read_b64_tr_b16 v[70:71], v15 offset:18944
    s_waitcnt lgkmcnt(4)
    s_waitcnt vmcnt(7)
    v_mfma_f32_32x32x16_bf16 v[32:47], v[72:75], v[124:127], v[32:47]
    v_mfma_f32_32x32x16_bf16 v[48:63], v[76:79], v[124:127], v[48:63]
    s_barrier
    buffer_load_dwordx4 v[124:127], v27, s[20:23], s62 offen sc1
    s_add_u32 s62, s62, 4096
    s_add_u32 m0, s79, 108544
    s_add_u32 s74, s78, 1245184
    buffer_load_dwordx4 v26, s[8:11], s74 offen lds
    ds_read_b64_tr_b16 v[72:73], v14 offset:26624
    ds_read_b64_tr_b16 v[74:75], v14 offset:27136
    ds_read_b64_tr_b16 v[76:77], v15 offset:26624
    ds_read_b64_tr_b16 v[78:79], v15 offset:27136
    s_waitcnt lgkmcnt(4)
    s_waitcnt vmcnt(8)
    v_mfma_f32_32x32x16_bf16 v[32:47], v[64:67], v[128:131], v[32:47]
    v_mfma_f32_32x32x16_bf16 v[48:63], v[68:71], v[128:131], v[48:63]
    buffer_load_dwordx4 v[128:131], v27, s[20:23], s62 offen sc1
    s_add_u32 s62, s62, 4096
    s_add_u32 m0, s79, 116736
    s_add_u32 s74, s78, 1310720
    buffer_load_dwordx4 v26, s[8:11], s74 offen lds
    ds_read_b64_tr_b16 v[64:65], v10 offset:0
    ds_read_b64_tr_b16 v[66:67], v10 offset:512
    ds_read_b64_tr_b16 v[68:69], v11 offset:0
    ds_read_b64_tr_b16 v[70:71], v11 offset:512
    s_waitcnt lgkmcnt(4)
    s_waitcnt vmcnt(9)
    v_mfma_f32_32x32x16_bf16 v[32:47], v[72:75], v[132:135], v[32:47]
    v_mfma_f32_32x32x16_bf16 v[48:63], v[76:79], v[132:135], v[48:63]
    buffer_load_dwordx4 v[132:135], v27, s[20:23], s62 offen sc1
    s_add_u32 s62, s62, 4096
    s_add_u32 m0, s79, 124928
    s_add_u32 s74, s78, 1376256
    buffer_load_dwordx4 v26, s[8:11], s74 offen lds
    ds_read_b64_tr_b16 v[72:73], v10 offset:8192
    ds_read_b64_tr_b16 v[74:75], v10 offset:8704
    ds_read_b64_tr_b16 v[76:77], v11 offset:8192
    ds_read_b64_tr_b16 v[78:79], v11 offset:8704
    s_waitcnt lgkmcnt(4)
    s_waitcnt vmcnt(10)
    v_mfma_f32_32x32x16_bf16 v[32:47], v[64:67], v[136:139], v[32:47]
    v_mfma_f32_32x32x16_bf16 v[48:63], v[68:71], v[136:139], v[48:63]
    buffer_load_dwordx4 v[136:139], v27, s[20:23], s62 offen sc1
    s_add_u32 s62, s62, 4096
    ds_read_b64_tr_b16 v[64:65], v10 offset:16384
    ds_read_b64_tr_b16 v[66:67], v10 offset:16896
    ds_read_b64_tr_b16 v[68:69], v11 offset:16384
    ds_read_b64_tr_b16 v[70:71], v11 offset:16896
    s_waitcnt lgkmcnt(4)
    s_waitcnt vmcnt(10)
    v_mfma_f32_32x32x16_bf16 v[32:47], v[72:75], v[140:143], v[32:47]
    v_mfma_f32_32x32x16_bf16 v[48:63], v[76:79], v[140:143], v[48:63]
    buffer_load_dwordx4 v[140:143], v27, s[20:23], s62 offen sc1
    s_add_u32 s62, s62, 4096
    ds_read_b64_tr_b16 v[72:73], v10 offset:24576
    ds_read_b64_tr_b16 v[74:75], v10 offset:25088
    ds_read_b64_tr_b16 v[76:77], v11 offset:24576
    ds_read_b64_tr_b16 v[78:79], v11 offset:25088
    s_waitcnt lgkmcnt(4)
    s_waitcnt vmcnt(10)
    v_mfma_f32_32x32x16_bf16 v[32:47], v[64:67], v[112:115], v[32:47]
    v_mfma_f32_32x32x16_bf16 v[48:63], v[68:71], v[112:115], v[48:63]
    buffer_load_dwordx4 v[112:115], v27, s[20:23], s62 offen sc1
    s_add_u32 s62, s62, 4096
    ds_read_b64_tr_b16 v[64:65], v10 offset:32768
    ds_read_b64_tr_b16 v[66:67], v10 offset:33280
    ds_read_b64_tr_b16 v[68:69], v11 offset:32768
    ds_read_b64_tr_b16 v[70:71], v11 offset:33280
    s_waitcnt lgkmcnt(4)
    s_waitcnt vmcnt(10)
    v_mfma_f32_32x32x16_bf16 v[32:47], v[72:75], v[116:119], v[32:47]
    v_mfma_f32_32x32x16_bf16 v[48:63], v[76:79], v[116:119], v[48:63]
    buffer_load_dwordx4 v[116:119], v27, s[20:23], s62 offen sc1
    s_add_u32 s62, s62, 4096
    ds_read_b64_tr_b16 v[72:73], v10 offset:43008
    ds_read_b64_tr_b16 v[74:75], v10 offset:43520
    ds_read_b64_tr_b16 v[76:77], v11 offset:43008
    ds_read_b64_tr_b16 v[78:79], v11 offset:43520
    s_waitcnt lgkmcnt(4)
    s_waitcnt vmcnt(10)
    v_mfma_f32_32x32x16_bf16 v[32:47], v[64:67], v[120:123], v[32:47]
    v_mfma_f32_32x32x16_bf16 v[48:63], v[68:71], v[120:123], v[48:63]
    buffer_load_dwordx4 v[120:123], v27, s[20:23], s62 offen sc1
    s_add_u32 s62, s62, 4096
    ds_read_b64_tr_b16 v[64:65], v10 offset:51200
    ds_read_b64_tr_b16 v[66:67], v10 offset:51712
    ds_read_b64_tr_b16 v[68:69], v11 offset:51200
    ds_read_b64_tr_b16 v[70:71], v11 offset:51712
    s_waitcnt lgkmcnt(4)
    s_waitcnt vmcnt(10)
    v_mfma_f32_32x32x16_bf16 v[32:47], v[72:75], v[124:127], v[32:47]
    v_mfma_f32_32x32x16_bf16 v[48:63], v[76:79], v[124:127], v[48:63]
    buffer_load_dwordx4 v[124:127], v27, s[20:23], s62 offen sc1
    s_add_u32 s62, s62, 4096
    ds_read_b64_tr_b16 v[72:73], v10 offset:59392
    ds_read_b64_tr_b16 v[74:75], v10 offset:59904
    ds_read_b64_tr_b16 v[76:77], v11 offset:59392
    ds_read_b64_tr_b16 v[78:79], v11 offset:59904
    s_waitcnt lgkmcnt(4)
    s_waitcnt vmcnt(9)
    v_mfma_f32_32x32x16_bf16 v[32:47], v[64:67], v[128:131], v[32:47]
    v_mfma_f32_32x32x16_bf16 v[48:63], v[68:71], v[128:131], v[48:63]
    buffer_load_dwordx4 v[128:131], v27, s[20:23], s62 offen sc1
    s_add_u32 s62, s62, 4096
    ds_read_b64_tr_b16 v[64:65], v12 offset:6144
    ds_read_b64_tr_b16 v[66:67], v12 offset:6656
    ds_read_b64_tr_b16 v[68:69], v13 offset:6144
    ds_read_b64_tr_b16 v[70:71], v13 offset:6656
    s_waitcnt lgkmcnt(4)
    s_waitcnt vmcnt(8)
    v_mfma_f32_32x32x16_bf16 v[32:47], v[72:75], v[132:135], v[32:47]
    v_mfma_f32_32x32x16_bf16 v[48:63], v[76:79], v[132:135], v[48:63]
    buffer_load_dwordx4 v[132:135], v27, s[20:23], s62 offen sc1
    s_add_u32 s62, s62, 4096
    ds_read_b64_tr_b16 v[72:73], v12 offset:14336
    ds_read_b64_tr_b16 v[74:75], v12 offset:14848
    ds_read_b64_tr_b16 v[76:77], v13 offset:14336
    ds_read_b64_tr_b16 v[78:79], v13 offset:14848
    s_waitcnt lgkmcnt(4)
    s_waitcnt vmcnt(7)
    v_mfma_f32_32x32x16_bf16 v[32:47], v[64:67], v[136:139], v[32:47]
    v_mfma_f32_32x32x16_bf16 v[48:63], v[68:71], v[136:139], v[48:63]
    ds_read_b64_tr_b16 v[64:65], v12 offset:22528
    ds_read_b64_tr_b16 v[66:67], v12 offset:23040
    ds_read_b64_tr_b16 v[68:69], v13 offset:22528
    ds_read_b64_tr_b16 v[70:71], v13 offset:23040
    s_waitcnt lgkmcnt(4)
    s_waitcnt vmcnt(6)
    v_mfma_f32_32x32x16_bf16 v[32:47], v[72:75], v[140:143], v[32:47]
    v_mfma_f32_32x32x16_bf16 v[48:63], v[76:79], v[140:143], v[48:63]
    buffer_load_dword v30, off, s[20:23], s81 offset:512 sc1
    ds_read_b64_tr_b16 v[72:73], v12 offset:30720
    ds_read_b64_tr_b16 v[74:75], v12 offset:31232
    ds_read_b64_tr_b16 v[76:77], v13 offset:30720
    ds_read_b64_tr_b16 v[78:79], v13 offset:31232
    s_waitcnt lgkmcnt(4)
    s_waitcnt vmcnt(6)
    v_mfma_f32_32x32x16_bf16 v[32:47], v[64:67], v[112:115], v[32:47]
    v_mfma_f32_32x32x16_bf16 v[48:63], v[68:71], v[112:115], v[48:63]
    ds_read_b64_tr_b16 v[64:65], v12 offset:38912
    ds_read_b64_tr_b16 v[66:67], v12 offset:39424
    ds_read_b64_tr_b16 v[68:69], v13 offset:38912
    ds_read_b64_tr_b16 v[70:71], v13 offset:39424
    s_waitcnt lgkmcnt(4)
    s_waitcnt vmcnt(5)
    v_mfma_f32_32x32x16_bf16 v[32:47], v[72:75], v[116:119], v[32:47]
    v_mfma_f32_32x32x16_bf16 v[48:63], v[76:79], v[116:119], v[48:63]
    s_barrier
    ds_read_b64_tr_b16 v[72:73], v12 offset:47104
    ds_read_b64_tr_b16 v[74:75], v12 offset:47616
    ds_read_b64_tr_b16 v[76:77], v13 offset:47104
    ds_read_b64_tr_b16 v[78:79], v13 offset:47616
    s_waitcnt lgkmcnt(4)
    s_waitcnt vmcnt(4)
    v_mfma_f32_32x32x16_bf16 v[32:47], v[64:67], v[120:123], v[32:47]
    v_mfma_f32_32x32x16_bf16 v[48:63], v[68:71], v[120:123], v[48:63]
    ds_read_b64_tr_b16 v[64:65], v12 offset:55296
    ds_read_b64_tr_b16 v[66:67], v12 offset:55808
    ds_read_b64_tr_b16 v[68:69], v13 offset:55296
    ds_read_b64_tr_b16 v[70:71], v13 offset:55808
    s_waitcnt lgkmcnt(4)
    s_waitcnt vmcnt(3)
    v_mfma_f32_32x32x16_bf16 v[32:47], v[72:75], v[124:127], v[32:47]
    v_mfma_f32_32x32x16_bf16 v[48:63], v[76:79], v[124:127], v[48:63]
    ds_read_b64_tr_b16 v[72:73], v14 offset:2048
    ds_read_b64_tr_b16 v[74:75], v14 offset:2560
    ds_read_b64_tr_b16 v[76:77], v15 offset:2048
    ds_read_b64_tr_b16 v[78:79], v15 offset:2560
    s_waitcnt lgkmcnt(4)
    s_waitcnt vmcnt(2)
    v_mfma_f32_32x32x16_bf16 v[32:47], v[64:67], v[128:131], v[32:47]
    v_mfma_f32_32x32x16_bf16 v[48:63], v[68:71], v[128:131], v[48:63]
    s_waitcnt vmcnt(0)
    v_readfirstlane_b32 s68, v30
    s_nop 0
    s_cmp_lt_u32 s68, 8
    s_cbranch_scc1 PMNE
    buffer_load_dwordx4 v[224:227], v27, s[20:23], s63 offen sc1
    s_add_u32 s63, s63, 4096
    buffer_load_dwordx4 v[228:231], v27, s[20:23], s63 offen sc1
    s_add_u32 s63, s63, 4096
    buffer_load_dwordx4 v[232:235], v27, s[20:23], s63 offen sc1
    s_add_u32 s63, s63, 4096
    buffer_load_dwordx4 v[236:239], v27, s[20:23], s63 offen sc1
    s_add_u32 s63, s63, 4096
    buffer_load_dwordx4 v[240:243], v27, s[20:23], s63 offen sc1
    s_add_u32 s63, s63, 4096
    buffer_load_dwordx4 v[244:247], v27, s[20:23], s63 offen sc1
    s_add_u32 s63, s63, 4096
    buffer_load_dwordx4 v[248:251], v27, s[20:23], s63 offen sc1
    s_add_u32 s63, s63, 4096
    buffer_load_dwordx4 v[252:255], v27, s[20:23], s63 offen sc1
    s_add_u32 s63, s63, 4096
    s_branch PME
PMNE:
    s_cmp_lg_u32 s58, 0
    s_cbranch_scc1 PMOI
    buffer_load_dword v30, off, s[20:23], s81 offset:512 sc1
PMOI:
PME:
    s_cmp_ge_u32 s66, 2
    s_cbranch_scc1 PMR
    s_waitcnt lgkmcnt(0)
    v_mfma_f32_32x32x16_bf16 v[32:47], v[72:75], v[132:135], v[32:47]
    v_mfma_f32_32x32x16_bf16 v[48:63], v[76:79], v[132:135], v[48:63]
PMR:
    s_mul_i32 s64, s66, 16896
    s_mul_i32 s65, s67, 8448
    s_add_u32 s64, s64, s65
    v_add_u32 v6, s64, v27
    s_nop 6
    ds_write_b128 v6, v[32:35] offset:0
    ds_write_b128 v6, v[36:39] offset:1056
    ds_write_b128 v6, v[40:43] offset:2112
    ds_write_b128 v6, v[44:47] offset:3168
    ds_write_b128 v6, v[48:51] offset:4224
    ds_write_b128 v6, v[52:55] offset:5280
    ds_write_b128 v6, v[56:59] offset:6336
    ds_write_b128 v6, v[60:63] offset:7392
    s_mul_i32 s64, s60, 8448
    s_lshl_b32 s65, s59, 7
    s_add_u32 s64, s64, s65
    v_lshrrev_b32 v2, 3, v1
    v_and_b32 v4, 7, v1
    v_mul_u32_u24 v4, 1056, v4
    v_lshl_add_u32 v4, v2, 4, v4
    v_add_u32 v8, s64, v4
    v_add_u32 v16, 67584, v6
    v_add_u32 v17, 67584, v8
    v_lshlrev_b32 v144, 16, v108
    v_and_b32 v145, 0xffff0000, v108
    v_lshlrev_b32 v152, 16, v104
    v_and_b32 v153, 0xffff0000, v104
    v_lshlrev_b32 v146, 16, v109
    v_and_b32 v147, 0xffff0000, v109
    v_lshlrev_b32 v154, 16, v105
    v_and_b32 v155, 0xffff0000, v105
    v_lshlrev_b32 v148, 16, v110
    v_and_b32 v149, 0xffff0000, v110
    v_lshlrev_b32 v156, 16, v106
    v_and_b32 v157, 0xffff0000, v106
    v_lshlrev_b32 v150, 16, v111
    v_and_b32 v151, 0xffff0000, v111
    v_lshlrev_b32 v158, 16, v107
    v_and_b32 v159, 0xffff0000, v107
    s_cmp_lt_u32 s68, 8
    s_cbranch_scc1 PMLT
    s_waitcnt vmcnt(7)
    v_mfma_f32_32x32x16_bf16 v[112:127], v[160:163], v[224:227], 0
    v_mfma_f32_32x32x16_bf16 v[128:143], v[164:167], v[224:227], 0
    s_waitcnt vmcnt(6)
    v_mfma_f32_32x32x16_bf16 v[112:127], v[168:171], v[228:231], v[112:127]
    v_mfma_f32_32x32x16_bf16 v[128:143], v[172:175], v[228:231], v[128:143]
    s_waitcnt vmcnt(5)
    v_mfma_f32_32x32x16_bf16 v[112:127], v[176:179], v[232:235], v[112:127]
    v_mfma_f32_32x32x16_bf16 v[128:143], v[180:183], v[232:235], v[128:143]
    s_waitcnt vmcnt(4)
    v_mfma_f32_32x32x16_bf16 v[112:127], v[184:187], v[236:239], v[112:127]
    v_mfma_f32_32x32x16_bf16 v[128:143], v[188:191], v[236:239], v[128:143]
    s_waitcnt vmcnt(3)
    v_mfma_f32_32x32x16_bf16 v[112:127], v[192:195], v[240:243], v[112:127]
    v_mfma_f32_32x32x16_bf16 v[128:143], v[196:199], v[240:243], v[128:143]
    s_waitcnt vmcnt(2)
    v_mfma_f32_32x32x16_bf16 v[112:127], v[200:203], v[244:247], v[112:127]
    v_mfma_f32_32x32x16_bf16 v[128:143], v[204:207], v[244:247], v[128:143]
    s_waitcnt vmcnt(1)
    v_mfma_f32_32x32x16_bf16 v[112:127], v[208:211], v[248:251], v[112:127]
    v_mfma_f32_32x32x16_bf16 v[128:143], v[212:215], v[248:251], v[128:143]
    s_waitcnt vmcnt(0)
    v_mfma_f32_32x32x16_bf16 v[112:127], v[216:219], v[252:255], v[112:127]
    v_mfma_f32_32x32x16_bf16 v[128:143], v[220:223], v[252:255], v[128:143]
    s_waitcnt lgkmcnt(0)
    s_barrier
    ds_read_b128 v[64:67], v8 offset:0
    ds_read_b128 v[68:71], v8 offset:512
    ds_read_b128 v[72:75], v8 offset:16896
    ds_read_b128 v[76:79], v8 offset:17408
    ds_read_b128 v[80:83], v8 offset:33792
    ds_read_b128 v[84:87], v8 offset:34304
    ds_read_b128 v[88:91], v8 offset:50688
    ds_read_b128 v[92:95], v8 offset:51200
    s_nop 0
    ds_write_b128 v16, v[112:115] offset:0
    ds_write_b128 v16, v[116:119] offset:1056
    ds_write_b128 v16, v[120:123] offset:2112
    ds_write_b128 v16, v[124:127] offset:3168
    ds_write_b128 v16, v[128:131] offset:4224
    ds_write_b128 v16, v[132:135] offset:5280
    ds_write_b128 v16, v[136:139] offset:6336
    ds_write_b128 v16, v[140:143] offset:7392
    s_waitcnt lgkmcnt(12)
    v_pk_add_f32 v[64:65], v[64:65], v[72:73]
    v_pk_add_f32 v[66:67], v[66:67], v[74:75]
    v_pk_add_f32 v[68:69], v[68:69], v[76:77]
    v_pk_add_f32 v[70:71], v[70:71], v[78:79]
    s_waitcnt lgkmcnt(8)
    v_pk_add_f32 v[80:81], v[80:81], v[88:89]
    v_pk_add_f32 v[82:83], v[82:83], v[90:91]
    v_pk_add_f32 v[84:85], v[84:85], v[92:93]
    v_pk_add_f32 v[86:87], v[86:87], v[94:95]
    v_pk_add_f32 v[96:97], v[64:65], v[80:81]
    v_pk_add_f32 v[98:99], v[66:67], v[82:83]
    v_pk_add_f32 v[100:101], v[68:69], v[84:85]
    v_pk_add_f32 v[102:103], v[70:71], v[86:87]
    v_pk_add_f32 v[96:97], v[96:97], v[144:145]
    v_pk_add_f32 v[98:99], v[98:99], v[146:147]
    v_pk_add_f32 v[100:101], v[100:101], v[148:149]
    v_pk_add_f32 v[102:103], v[102:103], v[150:151]
    v_mul_f32 v144, 0xbfb8aa3b, v96
    v_mul_f32 v145, 0xbfb8aa3b, v97
    v_mul_f32 v146, 0xbfb8aa3b, v98
    v_mul_f32 v147, 0xbfb8aa3b, v99
    v_mul_f32 v148, 0xbfb8aa3b, v100
    v_mul_f32 v149, 0xbfb8aa3b, v101
    v_mul_f32 v150, 0xbfb8aa3b, v102
    v_mul_f32 v151, 0xbfb8aa3b, v103
    v_exp_f32 v144, v144
    v_exp_f32 v145, v145
    v_exp_f32 v146, v146
    v_exp_f32 v147, v147
    v_exp_f32 v148, v148
    v_exp_f32 v149, v149
    v_exp_f32 v150, v150
    v_exp_f32 v151, v151
    v_add_f32 v144, 1.0, v144
    v_add_f32 v145, 1.0, v145
    v_add_f32 v146, 1.0, v146
    v_add_f32 v147, 1.0, v147
    v_add_f32 v148, 1.0, v148
    v_add_f32 v149, 1.0, v149
    v_add_f32 v150, 1.0, v150
    v_add_f32 v151, 1.0, v151
    v_rcp_f32 v144, v144
    v_rcp_f32 v145, v145
    v_rcp_f32 v146, v146
    v_rcp_f32 v147, v147
    v_rcp_f32 v148, v148
    v_rcp_f32 v149, v149
    v_rcp_f32 v150, v150
    v_rcp_f32 v151, v151
    v_pk_mul_f32 v[96:97], v[96:97], v[144:145]
    v_pk_mul_f32 v[98:99], v[98:99], v[146:147]
    v_pk_mul_f32 v[100:101], v[100:101], v[148:149]
    v_pk_mul_f32 v[102:103], v[102:103], v[150:151]
    s_barrier
    s_branch PMFN
PMLT:
    s_waitcnt lgkmcnt(0)
    s_barrier
    ds_read_b128 v[64:67], v8 offset:0
    ds_read_b128 v[68:71], v8 offset:512
    ds_read_b128 v[72:75], v8 offset:16896
    ds_read_b128 v[76:79], v8 offset:17408
    ds_read_b128 v[80:83], v8 offset:33792
    ds_read_b128 v[84:87], v8 offset:34304
    ds_read_b128 v[88:91], v8 offset:50688
    ds_read_b128 v[92:95], v8 offset:51200
    s_waitcnt lgkmcnt(4)
    v_pk_add_f32 v[64:65], v[64:65], v[72:73]
    v_pk_add_f32 v[66:67], v[66:67], v[74:75]
    v_pk_add_f32 v[68:69], v[68:69], v[76:77]
    v_pk_add_f32 v[70:71], v[70:71], v[78:79]
    s_waitcnt lgkmcnt(0)
    v_pk_add_f32 v[80:81], v[80:81], v[88:89]
    v_pk_add_f32 v[82:83], v[82:83], v[90:91]
    v_pk_add_f32 v[84:85], v[84:85], v[92:93]
    v_pk_add_f32 v[86:87], v[86:87], v[94:95]
    v_pk_add_f32 v[96:97], v[64:65], v[80:81]
    v_pk_add_f32 v[98:99], v[66:67], v[82:83]
    v_pk_add_f32 v[100:101], v[68:69], v[84:85]
    v_pk_add_f32 v[102:103], v[70:71], v[86:87]
    v_pk_add_f32 v[96:97], v[96:97], v[144:145]
    v_pk_add_f32 v[98:99], v[98:99], v[146:147]
    v_pk_add_f32 v[100:101], v[100:101], v[148:149]
    v_pk_add_f32 v[102:103], v[102:103], v[150:151]
    v_mul_f32 v144, 0xbfb8aa3b, v96
    v_mul_f32 v145, 0xbfb8aa3b, v97
    v_mul_f32 v146, 0xbfb8aa3b, v98
    v_mul_f32 v147, 0xbfb8aa3b, v99
    v_mul_f32 v148, 0xbfb8aa3b, v100
    v_mul_f32 v149, 0xbfb8aa3b, v101
    v_mul_f32 v150, 0xbfb8aa3b, v102
    v_mul_f32 v151, 0xbfb8aa3b, v103
    v_exp_f32 v144, v144
    v_exp_f32 v145, v145
    v_exp_f32 v146, v146
    v_exp_f32 v147, v147
    v_exp_f32 v148, v148
    v_exp_f32 v149, v149
    v_exp_f32 v150, v150
    v_exp_f32 v151, v151
    v_add_f32 v144, 1.0, v144
    v_add_f32 v145, 1.0, v145
    v_add_f32 v146, 1.0, v146
    v_add_f32 v147, 1.0, v147
    v_add_f32 v148, 1.0, v148
    v_add_f32 v149, 1.0, v149
    v_add_f32 v150, 1.0, v150
    v_add_f32 v151, 1.0, v151
    v_rcp_f32 v144, v144
    v_rcp_f32 v145, v145
    v_rcp_f32 v146, v146
    v_rcp_f32 v147, v147
    v_rcp_f32 v148, v148
    v_rcp_f32 v149, v149
    v_rcp_f32 v150, v150
    v_rcp_f32 v151, v151
    v_pk_mul_f32 v[96:97], v[96:97], v[144:145]
    v_pk_mul_f32 v[98:99], v[98:99], v[146:147]
    v_pk_mul_f32 v[100:101], v[100:101], v[148:149]
    v_pk_mul_f32 v[102:103], v[102:103], v[150:151]
    s_waitcnt vmcnt(0)
    s_cmp_lg_u32 s58, 0
    s_cbranch_scc1 PMOD
    s_mov_b32 s80, 400000
PMO:
    v_readfirstlane_b32 s65, v30
    s_nop 0
    s_cmp_ge_u32 s65, 8
    s_cbranch_scc1 PMOD
    s_sub_u32 s80, s80, 1
    s_cbranch_scc1 PMOD
    buffer_load_dword v30, off, s[20:23], s81 offset:512 sc1
    s_waitcnt vmcnt(0)
    s_branch PMO
PMOD:
    s_barrier
    buffer_load_dwordx4 v[224:227], v27, s[20:23], s63 offen sc1
    s_add_u32 s63, s63, 4096
    buffer_load_dwordx4 v[228:231], v27, s[20:23], s63 offen sc1
    s_add_u32 s63, s63, 4096
    buffer_load_dwordx4 v[232:235], v27, s[20:23], s63 offen sc1
    s_add_u32 s63, s63, 4096
    buffer_load_dwordx4 v[236:239], v27, s[20:23], s63 offen sc1
    s_add_u32 s63, s63, 4096
    buffer_load_dwordx4 v[240:243], v27, s[20:23], s63 offen sc1
    s_add_u32 s63, s63, 4096
    buffer_load_dwordx4 v[244:247], v27, s[20:23], s63 offen sc1
    s_add_u32 s63, s63, 4096
    buffer_load_dwordx4 v[248:251], v27, s[20:23], s63 offen sc1
    s_add_u32 s63, s63, 4096
    buffer_load_dwordx4 v[252:255], v27, s[20:23], s63 offen sc1
    s_add_u32 s63, s63, 4096
    s_waitcnt vmcnt(7)
    v_mfma_f32_32x32x16_bf16 v[112:127], v[160:163], v[224:227], 0
    v_mfma_f32_32x32x16_bf16 v[128:143], v[164:167], v[224:227], 0
    s_waitcnt vmcnt(6)
    v_mfma_f32_32x32x16_bf16 v[112:127], v[168:171], v[228:231], v[112:127]
    v_mfma_f32_32x32x16_bf16 v[128:143], v[172:175], v[228:231], v[128:143]
    s_waitcnt vmcnt(5)
    v_mfma_f32_32x32x16_bf16 v[112:127], v[176:179], v[232:235], v[112:127]
    v_mfma_f32_32x32x16_bf16 v[128:143], v[180:183], v[232:235], v[128:143]
    s_waitcnt vmcnt(4)
    v_mfma_f32_32x32x16_bf16 v[112:127], v[184:187], v[236:239], v[112:127]
    v_mfma_f32_32x32x16_bf16 v[128:143], v[188:191], v[236:239], v[128:143]
    s_waitcnt vmcnt(3)
    v_mfma_f32_32x32x16_bf16 v[112:127], v[192:195], v[240:243], v[112:127]
    v_mfma_f32_32x32x16_bf16 v[128:143], v[196:199], v[240:243], v[128:143]
    s_waitcnt vmcnt(2)
    v_mfma_f32_32x32x16_bf16 v[112:127], v[200:203], v[244:247], v[112:127]
    v_mfma_f32_32x32x16_bf16 v[128:143], v[204:207], v[244:247], v[128:143]
    s_waitcnt vmcnt(1)
    v_mfma_f32_32x32x16_bf16 v[112:127], v[208:211], v[248:251], v[112:127]
    v_mfma_f32_32x32x16_bf16 v[128:143], v[212:215], v[248:251], v[128:143]
    s_waitcnt vmcnt(0)
    v_mfma_f32_32x32x16_bf16 v[112:127], v[216:219], v[252:255], v[112:127]
    v_mfma_f32_32x32x16_bf16 v[128:143], v[220:223], v[252:255], v[128:143]
    s_nop 10
    ds_write_b128 v16, v[112:115] offset:0
    ds_write_b128 v16, v[116:119] offset:1056
    ds_write_b128 v16, v[120:123] offset:2112
    ds_write_b128 v16, v[124:127] offset:3168
    ds_write_b128 v16, v[128:131] offset:4224
    ds_write_b128 v16, v[132:135] offset:5280
    ds_write_b128 v16, v[136:139] offset:6336
    ds_write_b128 v16, v[140:143] offset:7392
PMFN:
    s_waitcnt lgkmcnt(0)
    s_barrier
    ds_read_b128 v[64:67], v17 offset:0
    ds_read_b128 v[68:71], v17 offset:512
    ds_read_b128 v[72:75], v17 offset:16896
    ds_read_b128 v[76:79], v17 offset:17408
    ds_read_b128 v[80:83], v17 offset:33792
    ds_read_b128 v[84:87], v17 offset:34304
    ds_read_b128 v[88:91], v17 offset:50688
    ds_read_b128 v[92:95], v17 offset:51200
    s_waitcnt lgkmcnt(4)
    v_pk_add_f32 v[64:65], v[64:65], v[72:73]
    v_pk_add_f32 v[66:67], v[66:67], v[74:75]
    v_pk_add_f32 v[68:69], v[68:69], v[76:77]
    v_pk_add_f32 v[70:71], v[70:71], v[78:79]
    s_waitcnt lgkmcnt(0)
    v_pk_add_f32 v[80:81], v[80:81], v[88:89]
    v_pk_add_f32 v[82:83], v[82:83], v[90:91]
    v_pk_add_f32 v[84:85], v[84:85], v[92:93]
    v_pk_add_f32 v[86:87], v[86:87], v[94:95]
    v_pk_add_f32 v[64:65], v[64:65], v[80:81]
    v_pk_add_f32 v[66:67], v[66:67], v[82:83]
    v_pk_add_f32 v[68:69], v[68:69], v[84:85]
    v_pk_add_f32 v[70:71], v[70:71], v[86:87]
    v_pk_fma_f32 v[152:153], v[64:65], v[96:97], v[152:153]
    v_pk_fma_f32 v[154:155], v[66:67], v[98:99], v[154:155]
    v_pk_fma_f32 v[156:157], v[68:69], v[100:101], v[156:157]
    v_pk_fma_f32 v[158:159], v[70:71], v[102:103], v[158:159]
    v_cvt_pk_bf16_f32 v104, v152, v153
    v_cvt_pk_bf16_f32 v105, v154, v155
    v_cvt_pk_bf16_f32 v106, v156, v157
    v_cvt_pk_bf16_f32 v107, v158, v159
    buffer_store_dwordx4 v[104:107], v7, s[16:19], s71 offen
K1_END:
K1_EXIT:
    s_endpgm
.section .rodata,"a"
.p2align 6
.amdhsa_kernel recurrent_scan__linear_kernel_hedgehog__mixer_channel_mlp__prompt_kernel
  .amdhsa_next_free_vgpr 256
  .amdhsa_next_free_sgpr 102
  .amdhsa_accum_offset 256
  .amdhsa_group_segment_fixed_size 0
  .amdhsa_kernarg_size 96
  .amdhsa_user_sgpr_count 2
  .amdhsa_user_sgpr_kernarg_segment_ptr 1
  .amdhsa_system_sgpr_workgroup_id_x 1
.end_amdhsa_kernel
```
